```python
import torch

def _softmax(x, axis=-1):
    return torch.softmax(x, dim=axis)

def _gelu(x):
    return torch.nn.functional.gelu(x, approximate='tanh')

def _silu(x):
    return torch.nn.functional.silu(x)

def _sigmoid(x):
    return torch.sigmoid(x)

def _layernorm(x, axis=-1, eps=1e-05):
    m = x.mean(dim=axis, keepdim=True)
    v = x.var(dim=axis, keepdim=True, unbiased=False)
    return (x - m) / torch.sqrt(v + eps)

def _scatter_add(tgt, idx, src, axis=0):
    return tgt.clone().index_add_(axis, idx, src)

def _segment_sum(src, seg, n):
    out = torch.zeros((n,) + src.shape[1:], dtype=src.dtype)
    return out.index_add_(0, seg, src)

def _pad(x, pw):
    flat = tuple((v for pair in reversed(pw) for v in pair))
    return torch.nn.functional.pad(x, flat)
kernel_name = 'adaLN_cond__sliding_local_dilated__glu_gated_glu__prompt'

def setup_inputs():

    _w = lambda a: (lambda t: t.to(torch.bfloat16) if t.is_floating_point() else t)(torch.as_tensor(a))

    def _A_setup():
        B, S, D = (1, 2048, 512)
        return {'x': _w((lambda *s: torch.randn(*s, dtype=torch.bfloat16) * 0.05)(B, S, D)), 'wqkv': _w((lambda *s: torch.randn(*s, dtype=torch.bfloat16) * 0.05)(D, 3 * D)), 'wo': _w((lambda *s: torch.randn(*s, dtype=torch.bfloat16) * 0.05)(D, D))}
    _A_in = _A_setup()

    def _B_setup():
        B, S, D, F = (1, 2048, 512, 1376)
        return {'x': _w((lambda *s: torch.randn(*s, dtype=torch.bfloat16) * 0.05)(B, S, D)), 'w_gate': _w((lambda *s: torch.randn(*s, dtype=torch.bfloat16) * 0.05)(D, F)), 'w_up': _w((lambda *s: torch.randn(*s, dtype=torch.bfloat16) * 0.05)(D, F)), 'w_down': _w((lambda *s: torch.randn(*s, dtype=torch.bfloat16) * 0.05)(F, D))}
    _B_in = _B_setup()
    return {'A_x': _A_in['x'], 'A_wqkv': _A_in['wqkv'], 'A_wo': _A_in['wo'], 'B_x': _B_in['x'], 'B_w_gate': _B_in['w_gate'], 'B_w_up': _B_in['w_up'], 'B_w_down': _B_in['w_down'], 'c': _w((lambda *s: torch.randn(*s, dtype=torch.bfloat16) * 0.1)(1, 512) * 8.0), 'w_mod': _w((lambda *s: torch.randn(*s, dtype=torch.bfloat16) * 0.1)(512, 6 * 512) * 512 ** (-0.5) * 8.0)}

def reference(A_x, A_wqkv, A_wo, B_x, B_w_gate, B_w_up, B_w_down, c, w_mod):

    def _A_ref(x, wqkv, wo):
        B, S, D = x.shape
        H = 32
        Dh = D // H
        W, dil = (8, 2)
        qkv = (lambda x, *d: x.permute(*d))((x @ wqkv).reshape(B, S, 3, H, Dh), 2, 0, 3, 1, 4)
        q, k, v = (qkv[0], qkv[1], qkv[2])
        scale = Dh ** (-0.5)
        pos = torch.arange(S)
        off = torch.arange(W) * dil
        idx = pos[:, None] - off[None, :]
        mask = idx >= 0
        idx_c = torch.where(mask, idx, 0).reshape(-1)
        kg = k[:, :, idx_c, :].reshape(B, H, S, W, Dh)
        vg = v[:, :, idx_c, :].reshape(B, H, S, W, Dh)
        logits = torch.einsum('bhsd,bhswd->bhsw', q, kg) * scale
        logits = torch.where(mask[None, None, :, :], logits, -1000000000.0)
        attn = _softmax(logits, axis=-1)
        o = torch.einsum('bhsw,bhswd->bhsd', attn, vg)
        return (lambda x, *d: x.permute(*d))(o, 0, 2, 1, 3).reshape(B, S, D) @ wo

    def _B_ref(x, w_gate, w_up, w_down):
        g = torch.einsum('bsd,df->bsf', x, w_gate)
        u = torch.einsum('bsd,df->bsf', x, w_up)
        h = _sigmoid(g) * u
        return torch.einsum('bsf,fd->bsd', h, w_down)
    x = A_x
    mod = (_silu(c) @ w_mod).reshape(c.shape[0], 6, 1, -1)
    sa, ca, ga, sb, cb, gb = (mod[:, 0].clone(), mod[:, 1].clone(), mod[:, 2].clone(), mod[:, 3].clone(), mod[:, 4].clone(), mod[:, 5].clone())
    h = _layernorm(x, axis=-1) * (1 + ca) + sa
    x = x + ga * _A_ref(h, A_wqkv, A_wo)
    h = _layernorm(x, axis=-1) * (1 + cb) + sb
    x = x + gb * _B_ref(h, B_w_gate, B_w_up, B_w_down)
    return x
```

```asm
; @launch grid=(256,1,1) block=(256,1,1) lds=163840
.amdgcn_target "amdgcn-amd-amdhsa--gfx950"
.text
.globl adaLN_cond__sliding_local_dilated__glu_gated_glu__prompt_kernel
.p2align 8
.type adaLN_cond__sliding_local_dilated__glu_gated_glu__prompt_kernel,@function
adaLN_cond__sliding_local_dilated__glu_gated_glu__prompt_kernel:
    s_cmp_ge_u32 s2, 256
    s_cbranch_scc1 L_end
    s_load_dwordx16 s[4:19], s[0:1], 0
    s_load_dwordx8 s[20:27], s[0:1], 64
    s_getpc_b64 s[94:95]
L_pcref:
    s_lshr_b32 s70, s2, 3
    s_lshl_b32 s88, s70, 11
    v_lshlrev_b32 v8, 7, v0
    v_add_u32 v8, s88, v8
    v_min_u32 v8, 0x7a3c, v8
    v_cmp_gt_u32 vcc, 16, v0
    s_nop 0
    s_and_saveexec_b64 s[92:93], vcc
    s_cbranch_execz L_noct
    global_load_dword v14, v8, s[94:95]
L_noct:
    s_mov_b64 exec, -1
    v_lshrrev_b32 v8, 6, v0
    v_and_b32 v1, 63, v0
    v_readfirstlane_b32 s68, v8
    v_lshlrev_b32 v2, 4, v1
    v_lshlrev_b32 v3, 2, v1
    s_and_b32 s69, s2, 7
    s_lshr_b32 s71, s70, 3
    s_and_b32 s72, s70, 7
    s_and_b32 s73, s70, 15
    s_lshl_b32 s79, s69, 8
    s_lshl_b32 s89, s71, 6
    s_add_u32 s79, s79, s89
    v_lshrrev_b32 v8, 3, v1
    v_and_b32 v9, 7, v1
    v_and_b32 v10, 2, v8
    v_xor_b32 v9, v9, v10
    v_lshlrev_b32 v9, 4, v9
    v_xor_b32_e64 v10, 64, v9
    v_mul_u32_u24 v11, 6144, v8
    v_add_u32 v4, v11, v9
    v_add_u32 v5, v11, v10
    v_mul_u32_u24 v11, 3072, v8
    v_add_u32 v6, v11, v9
    v_add_u32 v7, v11, v10
    v_add_u32 v7, 24576, v7
    v_min_u32 v12, 19, v1
    v_lshlrev_b32 v12, 7, v12
    v_lshrrev_b32 v8, 4, v1
    v_and_b32 v9, 15, v1
    s_lshl_b32 s88, s68, 2
    v_add_u32 v10, s88, v8
    v_lshlrev_b32_e64 v10, 10, v10
    v_lshl_add_u32 v11, v9, 4, v10
    s_mul_i32 s85, s72, 80
    s_mul_i32 s89, s68, 20
    s_add_u32 s85, s85, s89
    s_lshl_b32 s85, s85, 7
    s_lshr_b32 s90, s70, 2
    s_lshl_b32 s90, s90, 3
    s_add_u32 s96, s90, s69
    s_and_b32 s97, s70, 3
    s_lshl_b32 s89, s97, 7
    s_lshl_b32 s90, s68, 5
    s_add_u32 s89, s89, s90
    s_mul_i32 s89, s89, 6144
    s_lshl_b32 s90, s96, 7
    s_add_u32 s98, s89, s90
    s_waitcnt lgkmcnt(0)
    s_mov_b32 s28, s4
    s_and_b32 s29, s5, 0xffff
    s_mov_b32 s30, 2097152
    s_mov_b32 s31, 0x20000
    s_add_i32 s89, s79, -16
    s_lshl_b32 s89, s89, 10
    s_add_i32 s85, s85, s89
    s_max_i32 s85, s85, 0
    buffer_load_dword v14, v12, s[28:31], s85 offen
    s_mov_b32 s56, s20
    s_and_b32 s57, s21, 0xffff
    s_mov_b32 s58, 3145728
    s_mov_b32 s59, 0x20000
    s_mov_b32 s52, s18
    s_and_b32 s53, s19, 0xffff
    s_mov_b32 s54, 1024
    s_mov_b32 s55, 0x20000
    s_cmp_lt_u32 s70, 8
    s_cbranch_scc0 L_c_1
    s_and_b32 s88, s70, 3
    s_lshl_b32 s88, s88, 8
    s_lshl_b32 s91, s68, 14
    buffer_load_dword a255, v3, s[52:55], s88 offen
    s_add_u32 m0, s91, 12288
    s_add_u32 s90, s98, 0
    buffer_load_dwordx4 v4, s[56:59], s90 offen lds
    s_add_u32 m0, s91, 13312
    s_add_u32 s90, s98, 49152
    buffer_load_dwordx4 v5, s[56:59], s90 offen lds
    s_add_u32 m0, s91, 14336
    s_add_u32 s90, s98, 98304
    buffer_load_dwordx4 v4, s[56:59], s90 offen lds
    s_add_u32 m0, s91, 15360
    s_add_u32 s90, s98, 147456
    buffer_load_dwordx4 v5, s[56:59], s90 offen lds
L_c_1:
    s_load_dword s75, s[26:27], 0
    s_mov_b32 s32, s6
    s_and_b32 s33, s7, 0xffff
    s_mov_b32 s34, 1572864
    s_mov_b32 s35, 0x20000
    s_mov_b32 s48, s16
    s_and_b32 s49, s17, 0xffff
    s_mov_b32 s50, 1409024
    s_mov_b32 s51, 0x20000
    s_lshl_b32 s11, s72, 7
    s_mul_i32 s4, s68, 49152
    s_add_u32 s4, s4, s11
    s_lshl_b32 s5, s68, 11
    s_mov_b32 s17, s4
    s_max_i32 s89, s89, 0
    buffer_load_dwordx4 v[176:179], v11, s[28:31], s89 offen offset:0
    buffer_load_dwordx4 v[180:183], v11, s[28:31], s89 offen offset:256
    buffer_load_dwordx4 v[184:187], v11, s[28:31], s89 offen offset:512
    buffer_load_dwordx4 v[188:191], v11, s[28:31], s89 offen offset:768
    s_cmp_ge_u32 s70, 8
    s_cbranch_scc0 L_c_2
    s_add_u32 s90, s79, 0
    s_lshl_b32 s90, s90, 10
    buffer_load_dwordx4 v[192:195], v11, s[28:31], s90 offen offset:0
    buffer_load_dwordx4 v[196:199], v11, s[28:31], s90 offen offset:256
    buffer_load_dwordx4 v[200:203], v11, s[28:31], s90 offen offset:512
    buffer_load_dwordx4 v[204:207], v11, s[28:31], s90 offen offset:768
L_c_2:
    s_mov_b32 s64, s26
    s_and_b32 s65, s27, 0xffff
    s_mov_b32 s66, 33554432
    s_mov_b32 s67, 0x20000
    s_mov_b32 s36, s8
    s_and_b32 s37, s9, 0xffff
    s_mov_b32 s38, 524288
    s_mov_b32 s39, 0x20000
    s_mov_b32 s40, s12
    s_and_b32 s41, s13, 0xffff
    s_mov_b32 s42, 1409024
    s_mov_b32 s43, 0x20000
    s_mov_b32 s44, s14
    s_and_b32 s45, s15, 0xffff
    s_mov_b32 s46, 1409024
    s_mov_b32 s47, 0x20000
    s_mov_b32 s60, s22
    s_and_b32 s61, s23, 0xffff
    s_mov_b32 s62, 2097152
    s_mov_b32 s63, 0x20000
    s_mul_i32 s25, s97, 12288
    s_lshl_b32 s90, s96, 8
    s_add_u32 s25, s25, s90
    s_lshl_b32 s90, s68, 6
    s_add_u32 s25, s25, s90
    s_add_u32 s25, s25, 65536
    s_lshl_b32 s88, s69, 1
    s_lshr_b32 s89, s70, 4
    s_add_u32 s88, s88, s89
    s_lshl_b32 s74, s88, 20
    s_add_u32 s74, s74, 2097152
    s_and_b32 s77, s68, 1
    s_lshr_b32 s78, s68, 1
    s_and_b32 s88, s71, 1
    s_lshl_b32 s99, s88, 1
    s_lshl_b32 s7, s70, 2
    s_add_u32 s7, s7, s68
    s_add_u32 s21, s69, 0
    s_and_b32 s21, s21, 3
    s_add_u32 s22, s69, 1
    s_and_b32 s22, s22, 3
    s_add_u32 s23, s69, 2
    s_and_b32 s23, s23, 3
    s_add_u32 s24, s69, 3
    s_and_b32 s24, s24, 3
    s_mul_i32 s12, s73, 192
    s_cmp_eq_u32 s73, 15
    s_cselect_b32 s12, 0x70000000, s12
    s_lshl_b32 s8, s73, 2
    s_add_u32 s8, s8, s68
    s_lshl_b32 s8, s8, 2
    s_add_u32 s8, s8, s74
    s_add_u32 s88, s99, s77
    s_mul_i32 s27, s88, 92160
    s_add_u32 s27, s27, s74
    s_add_u32 s27, s27, 65536
    s_mul_i32 s9, s99, 90
    s_lshl_b32 s89, s72, 2
    s_add_u32 s9, s9, s89
    s_add_u32 s9, s9, s68
    s_lshl_b32 s9, s9, 10
    s_add_u32 s9, s9, 65536
    s_mul_i32 s88, s68, 92160
    s_add_u32 s88, s88, s74
    s_add_u32 s88, s88, 65536
    s_mul_i32 s10, s73, 3712
    s_add_u32 s10, s10, s88
    s_add_u32 s10, s10, 32768
    s_mov_b32 s90, 0x7f000000
    s_lshl_b32 s89, s73, 12
    s_add_u32 s89, s89, s88
    s_add_u32 s89, s89, 32768
    s_cmp_lt_u32 s73, 15
    s_cselect_b32 s14, s89, s90
    s_add_u32 s89, s89, 2048
    s_cmp_lt_u32 s73, 14
    s_cselect_b32 s15, s89, s90
    s_lshl_b32 s89, s73, 11
    s_add_u32 s89, s89, s88
    s_cmp_lt_u32 s73, 14
    s_cselect_b32 s16, s89, s90
    s_lshl_b32 s88, s77, 5
    s_add_u32 s88, s88, s79
    s_lshl_b32 s88, s88, 10
    s_add_u32 s88, s88, s11
    s_lshl_b32 s89, s78, 6
    s_add_u32 s97, s88, s89
    v_lshrrev_b32 v60, 2, v9
    v_lshrrev_b32 v61, 3, v9
    v_and_b32 v62, 3, v9
    v_lshlrev_b32 v62, 3, v62
    v_and_b32 v63, 1, v8
    v_lshrrev_b32_e64 v64, 5, v1
    v_lshl_add_u32 v10, v8, 3, v60
    v_lshlrev_b32_e64 v10, 7, v10
    v_lshl_or_b32 v65, v63, 1, v61
    v_xor_b32_e64 v65, s68, v65
    v_lshl_add_u32 v10, v65, 5, v10
    v_add_u32 v13, v62, v10
    v_xor_b32 v65, s78, v61
    v_lshlrev_b32_e64 v65, 6, v65
    v_lshl_add_u32 v65, v63, 5, v65
    v_add_u32_e64 v65, v62, v65
    v_lshl_add_u32 v65, v60, 7, v65
    s_mul_i32 s88, s78, 12288
    s_add_u32 s88, s88, 81920
    v_lshl_add_u32 v66, v64, 10, v65
    v_add_u32_e64 v66, s88, v66
    v_accvgpr_write_b32 a219, v66
    v_lshl_add_u32 v66, v64, 9, v65
    v_accvgpr_write_b32 a220, v66
    v_lshl_add_u32 v65, v64, 2, v60
    v_lshlrev_b32_e64 v65, 6, v65
    v_mul_u32_u24 v66, 8224, v63
    v_add3_u32 v65, v65, v66, v62
    v_accvgpr_write_b32 a221, v65
    v_xor_b32 v65, v9, v8
    v_lshlrev_b32 v65, 4, v65
    v_lshl_add_u32 v65, v8, 8, v65
    v_accvgpr_write_b32 a218, v65
    s_lshl_b32 s88, s68, 1
    v_add_u32 v65, s88, v64
    v_and_b32 v66, 7, v9
    v_xor_b32 v65, v65, v66
    v_lshlrev_b32_e64 v65, 4, v65
    v_lshl_add_u32 v65, v9, 8, v65
    v_lshl_add_u32 v66, v63, 14, v65
    v_accvgpr_write_b32 a215, v66
    v_lshl_add_u32 v66, v63, 7, v65
    v_accvgpr_write_b32 a216, v66
    v_lshlrev_b32_e64 v65, 5, v9
    v_add_u32 v65, 155648, v65
    v_accvgpr_write_b32 a217, v65
    v_lshl_add_u32 v65, v9, 1, v63
    v_lshlrev_b32_e64 v65, 10, v65
    v_lshl_add_u32 v66, v64, 3, v65
    v_accvgpr_write_b32 a210, v66
    v_lshl_add_u32 v66, v64, 4, v65
    v_accvgpr_write_b32 a222, v66
    v_lshlrev_b32_e64 v65, 7, v9
    v_accvgpr_write_b32 a209, v65
    v_and_b32 v65, 31, v1
    v_lshlrev_b32 v65, 4, v65
    v_lshl_add_u32 v65, v64, 11, v65
    v_accvgpr_write_b32 a223, v65
    v_lshrrev_b32 v65, 3, v1
    v_and_b32 v66, 7, v1
    v_and_b32 v67, 2, v65
    v_lshlrev_b32 v67, 1, v67
    v_xor_b32 v67, v66, v67
    v_lshlrev_b32 v67, 4, v67
    v_lshl_add_u32 v67, v65, 10, v67
    v_accvgpr_write_b32 a214, v67
    v_and_b32 v67, 3, v65
    v_lshlrev_b32 v68, 4, v66
    v_lshl_add_u32 v67, v67, 11, v68
    s_lshl_b32 s88, s72, 8
    s_lshl_b32 s89, s78, 7
    s_add_u32 s88, s88, s89
    s_add_u32 s88, s88, 4096
    v_add_u32 v67, s88, v67
    v_accvgpr_write_b32 a208, v67
    s_add_u32 s88, s99, s77
    s_lshl_b32 s88, s88, 3
    s_add_u32 s88, s88, s72
    s_lshl_b32 s88, s88, 9
    s_add_u32 s88, s88, 4096
    v_lshlrev_b32 v66, 7, v66
    v_and_b32 v65, 1, v65
    v_mul_u32_u24 v65, 92160, v65
    v_add3_u32 v65, v65, v66, s9
    v_and_b32 v67, 0x1ff, v66
    v_add_u32 v67, s88, v67
    v_cmp_gt_u32 vcc, 0, v1
    v_min_u32 v66, 13, v9
    v_lshlrev_b32 v66, 7, v66
    s_add_u32 s9, s9, s74
    v_cndmask_b32 v65, v67, v65, vcc
    v_cmp_gt_u32 vcc, 32, v1
    v_lshrrev_b32 v67, 2, v1
    v_mul_u32_u24 v67, 2752, v67
    v_cndmask_b32_e64 v65, v66, v65, vcc
    v_accvgpr_write_b32 a211, v65
    v_lshl_add_u32 v67, v62, 1, v67
    v_accvgpr_write_b32 a212, v67
    s_lshl_b32 s9, s72, 2
    s_add_u32 s9, s9, s68
    s_add_u32 s9, s9, s79
    s_lshl_b32 s9, s9, 10
    s_lshl_b32 s10, s77, 5
    s_add_u32 s10, s10, s79
    s_lshl_b32 s10, s10, 10
    v_lshlrev_b32 v60, 2, v8
    v_mov_b32 v61, 0xf149f2ca
    s_cmp_eq_u32 s79, 0
    s_cselect_b32 s91, 64, 0
    v_add_u32 v62, 9, v9
    v_add_u32 v63, s91, v62
    v_add_u32 v64, -8, v63
    v_add_u32 v65, 0, v60
    v_sub_u32 v66, v9, v65
    v_cmp_gt_u32 vcc, 8, v66
    v_cmp_ge_u32 s[94:95], v65, v62
    v_cmp_ge_u32 s[92:93], v65, v63
    v_cndmask_b32_e64 v67, v61, 0, vcc
    v_cndmask_b32_e64 v68, v61, 0, s[94:95]
    v_cndmask_b32_e64 v69, v61, 0, s[92:93]
    v_cmp_ge_u32_e64 vcc, v65, v64
    v_cmp_gt_u32 s[94:95], 8, v65
    v_accvgpr_write_b32 a192, v67
    v_accvgpr_write_b32 a196, v68
    v_accvgpr_write_b32 a204, v69
    s_and_b64 vcc, vcc, s[94:95]
    v_cndmask_b32_e64 v67, v61, 0, vcc
    v_accvgpr_write_b32 a200, v67
    v_add_u32 v65, 1, v60
    v_sub_u32 v66, v9, v65
    v_cmp_gt_u32 vcc, 8, v66
    v_cmp_ge_u32 s[94:95], v65, v62
    v_cmp_ge_u32 s[92:93], v65, v63
    v_cndmask_b32_e64 v67, v61, 0, vcc
    v_cndmask_b32_e64 v68, v61, 0, s[94:95]
    v_cndmask_b32_e64 v69, v61, 0, s[92:93]
    v_cmp_ge_u32_e64 vcc, v65, v64
    v_cmp_gt_u32 s[94:95], 8, v65
    v_accvgpr_write_b32 a193, v67
    v_accvgpr_write_b32 a197, v68
    v_accvgpr_write_b32 a205, v69
    s_and_b64 vcc, vcc, s[94:95]
    v_cndmask_b32_e64 v67, v61, 0, vcc
    v_accvgpr_write_b32 a201, v67
    v_add_u32 v65, 2, v60
    v_sub_u32 v66, v9, v65
    v_cmp_gt_u32 vcc, 8, v66
    v_cmp_ge_u32 s[94:95], v65, v62
    v_cmp_ge_u32 s[92:93], v65, v63
    v_cndmask_b32_e64 v67, v61, 0, vcc
    v_cndmask_b32_e64 v68, v61, 0, s[94:95]
    v_cndmask_b32_e64 v69, v61, 0, s[92:93]
    v_cmp_ge_u32_e64 vcc, v65, v64
    v_cmp_gt_u32 s[94:95], 8, v65
    v_accvgpr_write_b32 a194, v67
    v_accvgpr_write_b32 a198, v68
    v_accvgpr_write_b32 a206, v69
    s_and_b64 vcc, vcc, s[94:95]
    v_cndmask_b32_e64 v67, v61, 0, vcc
    v_accvgpr_write_b32 a202, v67
    v_add_u32 v65, 3, v60
    v_sub_u32 v66, v9, v65
    v_cmp_gt_u32 vcc, 8, v66
    v_cmp_ge_u32 s[94:95], v65, v62
    v_cmp_ge_u32 s[92:93], v65, v63
    v_cndmask_b32_e64 v67, v61, 0, vcc
    v_cndmask_b32_e64 v68, v61, 0, s[94:95]
    v_cndmask_b32_e64 v69, v61, 0, s[92:93]
    v_cmp_ge_u32_e64 vcc, v65, v64
    v_cmp_gt_u32 s[94:95], 8, v65
    v_accvgpr_write_b32 a195, v67
    v_accvgpr_write_b32 a199, v68
    v_accvgpr_write_b32 a207, v69
    s_and_b64 vcc, vcc, s[94:95]
    v_cndmask_b32_e64 v67, v61, 0, vcc
    v_accvgpr_write_b32 a203, v67
    s_nop 0
    s_waitcnt lgkmcnt(0)
    s_mul_i32 s75, s75, 0x9E3779B1
    s_add_u32 s75, s75, 0x7F4A7C15
    s_lshr_b32 s80, s75, 0
    s_and_b32 s80, s80, 0xff
    s_lshr_b32 s81, s75, 8
    s_and_b32 s81, s81, 0xff
    s_lshr_b32 s82, s75, 16
    s_and_b32 s82, s82, 0xff
    s_lshr_b32 s83, s75, 24
    s_and_b32 s83, s83, 0xff
    s_getreg_b32 s76, hwreg(HW_REG_XCC_ID, 0, 4)
    s_cmp_lt_u32 s70, 8
    s_cbranch_scc0 L_c_3
    s_waitcnt vmcnt(8)
    v_accvgpr_read_b32 v21, a255
    v_lshlrev_b32 v20, 16, v21
    v_and_b32 v21, 0xffff0000, v21
    v_mul_f32 v22, 0xbfb8aa3b, v20
    v_mul_f32 v23, 0xbfb8aa3b, v21
    v_exp_f32 v22, v22
    v_exp_f32 v23, v23
    v_add_f32 v22, 1.0, v22
    v_add_f32 v23, 1.0, v23
    v_rcp_f32 v22, v22
    v_rcp_f32 v23, v23
    s_lshl_b32 s88, s68, 8
    s_add_u32 s88, s88, 159744
    v_mul_f32 v20, v20, v22
    v_mul_f32_e64 v21, v21, v23
    v_cvt_pk_bf16_f32 v20, v20, v21
    v_add_u32 v21, s88, v3
    v_and_b32 v22, 48, v1
    v_add_u32_e64 v23, s88, v22
    ds_write_b32 v21, v20
    ds_read_b128 v[28:31], v23 offset:0
    ds_read_b128 v[32:35], v23 offset:64
    ds_read_b128 v[36:39], v23 offset:128
    ds_read_b128 v[40:43], v23 offset:192
    v_mov_b32 v21, 0xffffff00
    s_waitcnt vmcnt(4)
    s_barrier
    ds_read_b64_tr_b16 v[44:45], v13 offset:12288
    ds_read_b64_tr_b16 v[46:47], v13 offset:12800
    ds_read_b64_tr_b16 v[48:49], v13 offset:28672
    ds_read_b64_tr_b16 v[50:51], v13 offset:29184
    ds_read_b64_tr_b16 v[52:53], v13 offset:45056
    ds_read_b64_tr_b16 v[54:55], v13 offset:45568
    ds_read_b64_tr_b16 v[56:57], v13 offset:61440
    ds_read_b64_tr_b16 v[58:59], v13 offset:61952
    s_waitcnt lgkmcnt(6)
    v_mfma_f32_16x16x32_bf16 v[24:27], v[44:47], v[28:31], 0
    s_waitcnt lgkmcnt(4)
    v_mfma_f32_16x16x32_bf16 v[24:27], v[48:51], v[32:35], v[24:27]
    s_waitcnt lgkmcnt(2)
    v_mfma_f32_16x16x32_bf16 v[24:27], v[52:55], v[36:39], v[24:27]
    s_waitcnt lgkmcnt(0)
    v_mfma_f32_16x16x32_bf16 v[24:27], v[56:59], v[40:43], v[24:27]
    s_nop 7
    s_nop 0
    v_and_or_b32 v24, v24, v21, s80
    v_and_or_b32 v25, v25, v21, s81
    v_and_or_b32 v26, v26, v21, s82
    v_and_or_b32 v27, v27, v21, s83
    s_mov_b32 exec_lo, 0x00010001
    s_mov_b32 exec_hi, 0x00010001
    buffer_store_dwordx4 v[24:27], v22, s[64:67], s25 offen sc1
    s_mov_b64 exec, -1
L_c_3:
    s_sub_u32 s88, s70, 8
    s_cmp_lt_u32 s88, 16
    s_cselect_b32 s25, s25, 0x7f000000
    s_cselect_b32 s98, s98, 0x7f000000
    s_mov_b32 s1, 0x3f803f80
    s_mov_b32 s3, 0xffff0000
    s_cmp_lt_u32 s70, 8
    s_cbranch_scc0 L_c_4
    s_add_u32 s90, s79, 0
    s_lshl_b32 s90, s90, 10
    buffer_load_dwordx4 v[192:195], v11, s[28:31], s90 offen offset:0
    buffer_load_dwordx4 v[196:199], v11, s[28:31], s90 offen offset:256
    buffer_load_dwordx4 v[200:203], v11, s[28:31], s90 offen offset:512
    buffer_load_dwordx4 v[204:207], v11, s[28:31], s90 offen offset:768
L_c_4:
    s_add_u32 s90, s79, 16
    s_lshl_b32 s90, s90, 10
    buffer_load_dwordx4 v[208:211], v11, s[28:31], s90 offen offset:0
    buffer_load_dwordx4 v[212:215], v11, s[28:31], s90 offen offset:256
    buffer_load_dwordx4 v[216:219], v11, s[28:31], s90 offen offset:512
    buffer_load_dwordx4 v[220:223], v11, s[28:31], s90 offen offset:768
    s_add_u32 s90, s79, 32
    s_lshl_b32 s90, s90, 10
    buffer_load_dwordx4 v[224:227], v11, s[28:31], s90 offen offset:0
    buffer_load_dwordx4 v[228:231], v11, s[28:31], s90 offen offset:256
    buffer_load_dwordx4 v[232:235], v11, s[28:31], s90 offen offset:512
    buffer_load_dwordx4 v[236:239], v11, s[28:31], s90 offen offset:768
    s_add_u32 s90, s79, 48
    s_lshl_b32 s90, s90, 10
    buffer_load_dwordx4 v[240:243], v11, s[28:31], s90 offen offset:0
    buffer_load_dwordx4 v[244:247], v11, s[28:31], s90 offen offset:256
    buffer_load_dwordx4 v[248:251], v11, s[28:31], s90 offen offset:512
    buffer_load_dwordx4 v[252:255], v11, s[28:31], s90 offen offset:768
    s_waitcnt vmcnt(15)
    v_dot2_f32_bf16 v8, v176, s1, 0
    v_dot2_f32_bf16 v9, v176, v176, 0
    v_dot2_f32_bf16 v8, v177, s1, v8
    v_dot2_f32_bf16 v9, v177, v177, v9
    v_dot2_f32_bf16 v8, v178, s1, v8
    v_min_u32_e64 v175, 11, v1
    v_dot2_f32_bf16 v9, v178, v178, v9
    v_lshlrev_b32_e64 v175, 7, v175
    v_dot2_f32_bf16 v8, v179, s1, v8
    v_dot2_f32_bf16 v9, v179, v179, v9
    s_lshl_b32 s13, s69, 7
    s_waitcnt vmcnt(14)
    v_dot2_f32_bf16 v8, v180, s1, v8
    v_dot2_f32_bf16 v9, v180, v180, v9
    s_add_u32 s13, s13, s7
    s_nop 0
    v_dot2_f32_bf16 v8, v181, s1, v8
    v_dot2_f32_bf16 v9, v181, v181, v9
    s_mul_i32 s13, s13, 1536
    v_dot2_f32_bf16 v8, v182, s1, v8
    v_dot2_f32_bf16 v9, v182, v182, v9
    buffer_load_dword v14, v175, s[32:35], s13 offen
    v_dot2_f32_bf16 v8, v183, s1, v8
    v_min_u32_e64 v175, 2, v1
    v_dot2_f32_bf16 v9, v183, v183, v9
    s_waitcnt vmcnt(14)
    v_dot2_f32_bf16 v8, v184, s1, v8
    v_lshlrev_b32 v175, 10, v175
    v_dot2_f32_bf16 v9, v184, v184, v9
    v_dot2_f32_bf16 v8, v185, s1, v8
    s_mul_i32 s13, s7, 3072
    v_dot2_f32_bf16 v9, v185, v185, v9
    v_dot2_f32_bf16 v8, v186, s1, v8
    s_add_u32 s13, s13, 0
    v_dot2_f32_bf16 v9, v186, v186, v9
    v_dot2_f32_bf16 v8, v187, s1, v8
    buffer_load_dword v14, v175, s[32:35], s13 offen offset:384
    v_dot2_f32_bf16 v9, v187, v187, v9
    s_sub_u32 s88, s70, 8
    s_cmp_lt_u32 s88, 16
    s_cbranch_scc0 L_nolate
    s_and_b32 s88, s70, 3
    s_lshl_b32 s88, s88, 8
    s_lshl_b32 s91, s68, 14
    buffer_load_dword a255, v3, s[52:55], s88 offen
    s_add_u32 m0, s91, 12288
    s_add_u32 s90, s98, 0
    buffer_load_dwordx4 v4, s[56:59], s90 offen lds
    s_add_u32 m0, s91, 13312
    s_add_u32 s90, s98, 49152
    buffer_load_dwordx4 v5, s[56:59], s90 offen lds
    s_add_u32 m0, s91, 14336
    s_add_u32 s90, s98, 98304
    buffer_load_dwordx4 v4, s[56:59], s90 offen lds
    s_add_u32 m0, s91, 15360
    s_add_u32 s90, s98, 147456
    buffer_load_dwordx4 v5, s[56:59], s90 offen lds
L_nolate:
    s_waitcnt vmcnt(14)
    v_dot2_f32_bf16 v8, v188, s1, v8
    v_dot2_f32_bf16 v9, v188, v188, v9
    s_cmp_lg_u32 s68, 3
    s_cbranch_scc1 L_noxcc
    v_mov_b32 v4, s76
    v_mov_b32 v5, s75
    s_lshl_b32 s88, s73, 7
    s_add_u32 s88, s88, s74
    s_mov_b64 exec, 1
    buffer_store_dwordx2 v[4:5], off, s[64:67], s88 offset:2048 sc1
    s_mov_b64 exec, -1
L_noxcc:
    v_dot2_f32_bf16 v8, v189, s1, v8
    v_dot2_f32_bf16 v9, v189, v189, v9
    v_min_u32 v175, 2, v1
    v_dot2_f32_bf16 v8, v190, s1, v8
    v_dot2_f32_bf16 v9, v190, v190, v9
    v_lshlrev_b32_e64 v175, 10, v175
    v_dot2_f32_bf16 v8, v191, s1, v8
    v_dot2_f32_bf16 v9, v191, v191, v9
    s_mul_i32 s13, s7, 3072
    s_nop 0
    s_nop 0
    v_add_f32_dpp v8, v8, v8 row_ror:8 row_mask:0xf bank_mask:0xf
    s_add_u32 s13, s13, 393216
    v_add_f32_dpp v9, v9, v9 row_ror:8 row_mask:0xf bank_mask:0xf
    v_add_f32_dpp v8, v8, v8 row_ror:4 row_mask:0xf bank_mask:0xf
    buffer_load_dword v14, v175, s[32:35], s13 offen offset:384
    v_add_f32_dpp v9, v9, v9 row_ror:4 row_mask:0xf bank_mask:0xf
    v_add_f32_dpp v8, v8, v8 row_ror:2 row_mask:0xf bank_mask:0xf
    s_add_u32 s4, s17, 0
    s_nop 0
    v_add_f32_dpp v9, v9, v9 row_ror:2 row_mask:0xf bank_mask:0xf
    v_add_f32_dpp v8, v8, v8 row_ror:1 row_mask:0xf bank_mask:0xf
    s_add_u32 m0, s5, 81920
    v_add_f32_dpp v9, v9, v9 row_ror:1 row_mask:0xf bank_mask:0xf
    v_mul_f32 v8, 0x3b000000, v8
    buffer_load_dwordx4 v6, s[32:35], s4 offen lds
    v_mul_f32 v9, 0x3b000000, v9
    s_add_u32 m0, s5, 82944
    v_fma_f32 v9, -v8, v8, v9
    v_max_f32_e64 v9, 0, v9
    buffer_load_dwordx4 v7, s[32:35], s4 offen lds
    v_add_f32 v9, 0x3727c5ac, v9
    v_rsq_f32_e64 v10, v9
    s_add_u32 m0, s5, 89088
    v_cvt_pk_bf16_f32 v10, v10, 0
    v_lshlrev_b32_e64 v12, 16, v10
    buffer_load_dwordx4 v6, s[32:35], s4 offen offset:1024 lds
    v_mul_f32_e64 v9, -v8, v12
    v_dot2_f32_bf16 v16, v176, v10, v9
    s_add_u32 m0, s5, 90112
    v_dot2_f32_bf16 v17, v176, v12, v9
    buffer_load_dwordx4 v7, s[32:35], s4 offen offset:1024 lds
    v_dot2_f32_bf16 v18, v177, v10, v9
    v_dot2_f32_bf16 v19, v177, v12, v9
    s_add_u32 m0, s5, 96256
    v_dot2_f32_bf16 v20, v178, v10, v9
    v_dot2_f32_bf16 v21, v178, v12, v9
    buffer_load_dwordx4 v6, s[32:35], s4 offen offset:2048 lds
    v_dot2_f32_bf16 v22, v179, v10, v9
    v_dot2_f32_bf16 v23, v179, v12, v9
    s_add_u32 m0, s5, 97280
    v_dot2_f32_bf16 v56, v180, v10, v9
    v_dot2_f32_bf16 v57, v180, v12, v9
    buffer_load_dwordx4 v7, s[32:35], s4 offen offset:2048 lds
    v_dot2_f32_bf16 v58, v181, v10, v9
    v_dot2_f32_bf16 v59, v181, v12, v9
    v_dot2_f32_bf16 v60, v182, v10, v9
    v_dot2_f32_bf16 v61, v182, v12, v9
    v_dot2_f32_bf16 v62, v183, v10, v9
    v_dot2_f32_bf16 v63, v183, v12, v9
    v_dot2_f32_bf16 v96, v184, v10, v9
    v_dot2_f32_bf16 v97, v184, v12, v9
    v_dot2_f32_bf16 v98, v185, v10, v9
    v_dot2_f32_bf16 v99, v185, v12, v9
    v_dot2_f32_bf16 v100, v186, v10, v9
    v_dot2_f32_bf16 v101, v186, v12, v9
    v_dot2_f32_bf16 v102, v187, v10, v9
    v_dot2_f32_bf16 v103, v187, v12, v9
    v_dot2_f32_bf16 v136, v188, v10, v9
    v_dot2_f32_bf16 v137, v188, v12, v9
    v_dot2_f32_bf16 v138, v189, v10, v9
    v_dot2_f32_bf16 v139, v189, v12, v9
    v_dot2_f32_bf16 v140, v190, v10, v9
    v_dot2_f32_bf16 v141, v190, v12, v9
    v_dot2_f32_bf16 v142, v191, v10, v9
    v_dot2_f32_bf16 v143, v191, v12, v9
    s_waitcnt vmcnt(24)
    s_nop 0
    v_dot2_f32_bf16 v8, v192, s1, 0
    v_dot2_f32_bf16 v9, v192, v192, 0
    v_dot2_f32_bf16 v8, v193, s1, v8
    v_dot2_f32_bf16 v9, v193, v193, v9
    v_dot2_f32_bf16 v8, v194, s1, v8
    v_dot2_f32_bf16 v9, v194, v194, v9
    v_dot2_f32_bf16 v8, v195, s1, v8
    v_dot2_f32_bf16 v9, v195, v195, v9
    s_waitcnt vmcnt(23)
    s_nop 0
    v_dot2_f32_bf16 v8, v196, s1, v8
    v_dot2_f32_bf16 v9, v196, v196, v9
    s_add_u32 s4, s17, 196608
    v_dot2_f32_bf16 v8, v197, s1, v8
    v_dot2_f32_bf16 v9, v197, v197, v9
    v_dot2_f32_bf16 v8, v198, s1, v8
    v_dot2_f32_bf16 v9, v198, v198, v9
    v_dot2_f32_bf16 v8, v199, s1, v8
    s_add_u32 m0, s5, 106496
    v_dot2_f32_bf16 v9, v199, v199, v9
    s_waitcnt vmcnt(22)
    s_nop 0
    v_dot2_f32_bf16 v8, v200, s1, v8
    v_dot2_f32_bf16 v9, v200, v200, v9
    v_dot2_f32_bf16 v8, v201, s1, v8
    v_dot2_f32_bf16 v9, v201, v201, v9
    buffer_load_dwordx4 v6, s[32:35], s4 offen lds
    v_dot2_f32_bf16 v8, v202, s1, v8
    v_dot2_f32_bf16 v9, v202, v202, v9
    v_dot2_f32_bf16 v8, v203, s1, v8
    v_dot2_f32_bf16 v9, v203, v203, v9
    s_waitcnt vmcnt(22)
    s_nop 0
    v_dot2_f32_bf16 v8, v204, s1, v8
    s_add_u32 m0, s5, 107520
    v_dot2_f32_bf16 v9, v204, v204, v9
    v_dot2_f32_bf16 v8, v205, s1, v8
    v_dot2_f32_bf16 v9, v205, v205, v9
    v_dot2_f32_bf16 v8, v206, s1, v8
    v_dot2_f32_bf16 v9, v206, v206, v9
    buffer_load_dwordx4 v7, s[32:35], s4 offen lds
    v_dot2_f32_bf16 v8, v207, s1, v8
    v_dot2_f32_bf16 v9, v207, v207, v9
    s_nop 1
    v_add_f32_dpp v8, v8, v8 row_ror:8 row_mask:0xf bank_mask:0xf
    v_add_f32_dpp v9, v9, v9 row_ror:8 row_mask:0xf bank_mask:0xf
    s_nop 0
    v_add_f32_dpp v8, v8, v8 row_ror:4 row_mask:0xf bank_mask:0xf
    s_add_u32 m0, s5, 113664
    v_add_f32_dpp v9, v9, v9 row_ror:4 row_mask:0xf bank_mask:0xf
    v_add_f32_dpp v8, v8, v8 row_ror:2 row_mask:0xf bank_mask:0xf
    s_nop 0
    v_add_f32_dpp v9, v9, v9 row_ror:2 row_mask:0xf bank_mask:0xf
    v_add_f32_dpp v8, v8, v8 row_ror:1 row_mask:0xf bank_mask:0xf
    s_nop 0
    v_add_f32_dpp v9, v9, v9 row_ror:1 row_mask:0xf bank_mask:0xf
    buffer_load_dwordx4 v6, s[32:35], s4 offen offset:1024 lds
    v_mul_f32 v8, 0x3b000000, v8
    v_mul_f32 v9, 0x3b000000, v9
    v_fma_f32 v9, -v8, v8, v9
    v_max_f32_e64 v9, 0, v9
    v_add_f32 v9, 0x3727c5ac, v9
    s_add_u32 m0, s5, 114688
    v_rsq_f32 v10, v9
    s_nop 0
    v_cvt_pk_bf16_f32 v10, v10, 0
    v_lshlrev_b32_e64 v12, 16, v10
    v_mul_f32_e64 v9, -v8, v12
    v_dot2_f32_bf16 v24, v192, v10, v9
    buffer_load_dwordx4 v7, s[32:35], s4 offen offset:1024 lds
    v_dot2_f32_bf16 v25, v192, v12, v9
    v_dot2_f32_bf16 v26, v193, v10, v9
    v_dot2_f32_bf16 v27, v193, v12, v9
    v_dot2_f32_bf16 v28, v194, v10, v9
    v_dot2_f32_bf16 v29, v194, v12, v9
    s_add_u32 m0, s5, 120832
    v_dot2_f32_bf16 v30, v195, v10, v9
    v_dot2_f32_bf16 v31, v195, v12, v9
    v_dot2_f32_bf16 v64, v196, v10, v9
    v_dot2_f32_bf16 v65, v196, v12, v9
    v_dot2_f32_bf16 v66, v197, v10, v9
    v_dot2_f32_bf16 v67, v197, v12, v9
    buffer_load_dwordx4 v6, s[32:35], s4 offen offset:2048 lds
    v_dot2_f32_bf16 v68, v198, v10, v9
    v_dot2_f32_bf16 v69, v198, v12, v9
    v_dot2_f32_bf16 v70, v199, v10, v9
    v_dot2_f32_bf16 v71, v199, v12, v9
    v_dot2_f32_bf16 v104, v200, v10, v9
    s_add_u32 m0, s5, 121856
    v_dot2_f32_bf16 v105, v200, v12, v9
    v_dot2_f32_bf16 v106, v201, v10, v9
    v_dot2_f32_bf16 v107, v201, v12, v9
    v_dot2_f32_bf16 v108, v202, v10, v9
    v_dot2_f32_bf16 v109, v202, v12, v9
    buffer_load_dwordx4 v7, s[32:35], s4 offen offset:2048 lds
    v_dot2_f32_bf16 v110, v203, v10, v9
    v_dot2_f32_bf16 v111, v203, v12, v9
    v_dot2_f32_bf16 v144, v204, v10, v9
    v_dot2_f32_bf16 v145, v204, v12, v9
    v_dot2_f32_bf16 v146, v205, v10, v9
    v_lshlrev_b32_e64 v4, 4, v0
    v_dot2_f32_bf16 v147, v205, v12, v9
    v_dot2_f32_bf16 v148, v206, v10, v9
    v_dot2_f32_bf16 v149, v206, v12, v9
    v_dot2_f32_bf16 v150, v207, v10, v9
    v_dot2_f32_bf16 v151, v207, v12, v9
    s_mov_b32 s13, 65536
    s_waitcnt vmcnt(26)
    s_nop 0
    v_dot2_f32_bf16 v8, v208, s1, 0
    v_dot2_f32_bf16 v9, v208, v208, 0
    v_dot2_f32_bf16 v8, v209, s1, v8
    v_dot2_f32_bf16 v9, v209, v209, v9
    v_dot2_f32_bf16 v8, v210, s1, v8
    buffer_load_dwordx4 v[176:179], v4, s[64:67], s13 offen sc1
    v_dot2_f32_bf16 v9, v210, v210, v9
    v_dot2_f32_bf16 v8, v211, s1, v8
    v_dot2_f32_bf16 v9, v211, v211, v9
    s_waitcnt vmcnt(26)
    s_nop 0
    v_dot2_f32_bf16 v8, v212, s1, v8
    v_dot2_f32_bf16 v9, v212, v212, v9
    s_mov_b32 s13, 77824
    v_dot2_f32_bf16 v8, v213, s1, v8
    v_dot2_f32_bf16 v9, v213, v213, v9
    v_dot2_f32_bf16 v8, v214, s1, v8
    v_dot2_f32_bf16 v9, v214, v214, v9
    v_dot2_f32_bf16 v8, v215, s1, v8
    buffer_load_dwordx4 v[180:183], v4, s[64:67], s13 offen sc1
    v_dot2_f32_bf16 v9, v215, v215, v9
    s_waitcnt vmcnt(26)
    s_nop 0
    v_dot2_f32_bf16 v8, v216, s1, v8
    v_dot2_f32_bf16 v9, v216, v216, v9
    v_dot2_f32_bf16 v8, v217, s1, v8
    v_dot2_f32_bf16 v9, v217, v217, v9
    s_mov_b32 s13, 90112
    v_dot2_f32_bf16 v8, v218, s1, v8
    v_dot2_f32_bf16 v9, v218, v218, v9
    v_dot2_f32_bf16 v8, v219, s1, v8
    v_dot2_f32_bf16 v9, v219, v219, v9
    s_waitcnt vmcnt(25)
    s_nop 0
    v_dot2_f32_bf16 v8, v220, s1, v8
    buffer_load_dwordx4 v[184:187], v4, s[64:67], s13 offen sc1
    v_dot2_f32_bf16 v9, v220, v220, v9
    v_dot2_f32_bf16 v8, v221, s1, v8
    v_dot2_f32_bf16 v9, v221, v221, v9
    v_dot2_f32_bf16 v8, v222, s1, v8
    v_dot2_f32_bf16 v9, v222, v222, v9
    v_dot2_f32_bf16 v8, v223, s1, v8
    s_mov_b32 s13, 102400
    v_dot2_f32_bf16 v9, v223, v223, v9
    s_nop 0
    v_add_f32_dpp v8, v8, v8 row_ror:8 row_mask:0xf bank_mask:0xf
    s_nop 0
    v_add_f32_dpp v9, v9, v9 row_ror:8 row_mask:0xf bank_mask:0xf
    v_add_f32_dpp v8, v8, v8 row_ror:4 row_mask:0xf bank_mask:0xf
    s_nop 0
    v_add_f32_dpp v9, v9, v9 row_ror:4 row_mask:0xf bank_mask:0xf
    buffer_load_dwordx4 v[188:191], v4, s[64:67], s13 offen sc1
    v_add_f32_dpp v8, v8, v8 row_ror:2 row_mask:0xf bank_mask:0xf
    v_add_f32_dpp v9, v9, v9 row_ror:2 row_mask:0xf bank_mask:0xf
    s_nop 0
    v_add_f32_dpp v8, v8, v8 row_ror:1 row_mask:0xf bank_mask:0xf
    v_add_f32_dpp v9, v9, v9 row_ror:1 row_mask:0xf bank_mask:0xf
    v_mul_f32 v8, 0x3b000000, v8
    v_min_u32_e64 v5, 2, v1
    v_mul_f32 v9, 0x3b000000, v9
    v_fma_f32 v9, -v8, v8, v9
    v_max_f32_e64 v9, 0, v9
    v_add_f32 v9, 0x3727c5ac, v9
    v_rsq_f32 v10, v9
    v_lshlrev_b32 v5, 10, v5
    v_cvt_pk_bf16_f32 v10, v10, 0
    v_lshlrev_b32_e64 v12, 16, v10
    v_mul_f32_e64 v9, -v8, v12
    v_dot2_f32_bf16 v32, v208, v10, v9
    v_dot2_f32_bf16 v33, v208, v12, v9
    s_mul_i32 s13, s7, 3072
    v_dot2_f32_bf16 v34, v209, v10, v9
    v_dot2_f32_bf16 v35, v209, v12, v9
    v_dot2_f32_bf16 v36, v210, v10, v9
    v_dot2_f32_bf16 v37, v210, v12, v9
    v_dot2_f32_bf16 v38, v211, v10, v9
    s_add_u32 s13, s13, 786432
    v_dot2_f32_bf16 v39, v211, v12, v9
    v_dot2_f32_bf16 v72, v212, v10, v9
    v_dot2_f32_bf16 v73, v212, v12, v9
    v_dot2_f32_bf16 v74, v213, v10, v9
    v_dot2_f32_bf16 v75, v213, v12, v9
    buffer_load_dword v14, v5, s[32:35], s13 offen offset:384
    v_dot2_f32_bf16 v76, v214, v10, v9
    v_dot2_f32_bf16 v77, v214, v12, v9
    v_dot2_f32_bf16 v78, v215, v10, v9
    v_dot2_f32_bf16 v79, v215, v12, v9
    v_dot2_f32_bf16 v112, v216, v10, v9
    s_add_u32 s4, s17, 393216
    v_dot2_f32_bf16 v113, v216, v12, v9
    v_dot2_f32_bf16 v114, v217, v10, v9
    v_dot2_f32_bf16 v115, v217, v12, v9
    v_dot2_f32_bf16 v116, v218, v10, v9
    v_dot2_f32_bf16 v117, v218, v12, v9
    s_add_u32 m0, s5, 131072
    v_dot2_f32_bf16 v118, v219, v10, v9
    v_dot2_f32_bf16 v119, v219, v12, v9
    v_dot2_f32_bf16 v152, v220, v10, v9
    v_dot2_f32_bf16 v153, v220, v12, v9
    v_dot2_f32_bf16 v154, v221, v10, v9
    buffer_load_dwordx4 v6, s[32:35], s4 offen lds
    v_dot2_f32_bf16 v155, v221, v12, v9
    v_dot2_f32_bf16 v156, v222, v10, v9
    v_dot2_f32_bf16 v157, v222, v12, v9
    v_dot2_f32_bf16 v158, v223, v10, v9
    v_dot2_f32_bf16 v159, v223, v12, v9
    s_waitcnt vmcnt(28)
    v_dot2_f32_bf16 v8, v224, s1, 0
    s_add_u32 m0, s5, 132096
    s_waitcnt vmcnt(23)
    v_accvgpr_read_b32 v193, a255
    v_dot2_f32_bf16 v9, v224, v224, 0
    v_dot2_f32_bf16 v8, v225, s1, v8
    v_dot2_f32_bf16 v9, v225, v225, v9
    v_lshlrev_b32_e64 v192, 16, v193
    v_dot2_f32_bf16 v8, v226, s1, v8
    v_dot2_f32_bf16 v9, v226, v226, v9
    buffer_load_dwordx4 v7, s[32:35], s4 offen lds
    v_dot2_f32_bf16 v8, v227, s1, v8
    v_and_b32 v193, 0xffff0000, v193
    v_dot2_f32_bf16 v9, v227, v227, v9
    v_dot2_f32_bf16 v8, v228, s1, v8
    v_dot2_f32_bf16 v9, v228, v228, v9
    v_mul_f32 v194, 0xbfb8aa3b, v192
    v_dot2_f32_bf16 v8, v229, s1, v8
    s_add_u32 m0, s5, 138240
    v_dot2_f32_bf16 v9, v229, v229, v9
    v_dot2_f32_bf16 v8, v230, s1, v8
    v_mul_f32 v195, 0xbfb8aa3b, v193
    v_dot2_f32_bf16 v9, v230, v230, v9
    v_dot2_f32_bf16 v8, v231, s1, v8
    v_dot2_f32_bf16 v9, v231, v231, v9
    buffer_load_dwordx4 v6, s[32:35], s4 offen offset:1024 lds
    v_exp_f32_e64 v194, v194
    v_dot2_f32_bf16 v8, v232, s1, v8
    v_dot2_f32_bf16 v9, v232, v232, v9
    v_dot2_f32_bf16 v8, v233, s1, v8
    v_exp_f32_e64 v195, v195
    v_dot2_f32_bf16 v9, v233, v233, v9
    v_dot2_f32_bf16 v8, v234, s1, v8
    s_add_u32 m0, s5, 139264
    v_dot2_f32_bf16 v9, v234, v234, v9
    v_add_f32_e64 v194, 1.0, v194
    v_dot2_f32_bf16 v8, v235, s1, v8
    v_dot2_f32_bf16 v9, v235, v235, v9
    v_dot2_f32_bf16 v8, v236, s1, v8
    v_add_f32_e64 v195, 1.0, v195
    v_dot2_f32_bf16 v9, v236, v236, v9
    buffer_load_dwordx4 v7, s[32:35], s4 offen offset:1024 lds
    v_dot2_f32_bf16 v8, v237, s1, v8
    v_dot2_f32_bf16 v9, v237, v237, v9
    v_rcp_f32_e64 v194, v194
    v_dot2_f32_bf16 v8, v238, s1, v8
    v_dot2_f32_bf16 v9, v238, v238, v9
    v_dot2_f32_bf16 v8, v239, s1, v8
    s_add_u32 m0, s5, 145408
    v_rcp_f32_e64 v195, v195
    v_dot2_f32_bf16 v9, v239, v239, v9
    v_add_f32_dpp v8, v8, v8 row_ror:8 row_mask:0xf bank_mask:0xf
    s_nop 1
    v_add_f32_dpp v9, v9, v9 row_ror:8 row_mask:0xf bank_mask:0xf
    s_lshl_b32 s88, s68, 8
    v_add_f32_dpp v8, v8, v8 row_ror:4 row_mask:0xf bank_mask:0xf
    v_add_f32_dpp v9, v9, v9 row_ror:4 row_mask:0xf bank_mask:0xf
    buffer_load_dwordx4 v6, s[32:35], s4 offen offset:2048 lds
    v_add_f32_dpp v8, v8, v8 row_ror:2 row_mask:0xf bank_mask:0xf
    s_add_u32 s88, s88, 159744
    v_add_f32_dpp v9, v9, v9 row_ror:2 row_mask:0xf bank_mask:0xf
    v_add_f32_dpp v8, v8, v8 row_ror:1 row_mask:0xf bank_mask:0xf
    s_nop 0
    v_add_f32_dpp v9, v9, v9 row_ror:1 row_mask:0xf bank_mask:0xf
    v_mul_f32 v8, 0x3b000000, v8
    s_add_u32 m0, s5, 146432
    v_mul_f32 v192, v192, v194
    v_mul_f32 v9, 0x3b000000, v9
    v_fma_f32 v9, -v8, v8, v9
    v_max_f32 v9, 0, v9
    v_mul_f32 v193, v193, v195
    v_add_f32 v9, 0x3727c5ac, v9
    v_rsq_f32_e64 v10, v9
    buffer_load_dwordx4 v7, s[32:35], s4 offen offset:2048 lds
    v_cvt_pk_bf16_f32 v10, v10, 0
    v_cvt_pk_bf16_f32 v192, v192, v193
    v_lshlrev_b32_e64 v12, 16, v10
    v_mul_f32_e64 v9, -v8, v12
    v_dot2_f32_bf16 v40, v224, v10, v9
    v_add_u32_e64 v193, s88, v3
    v_dot2_f32_bf16 v41, v224, v12, v9
    v_dot2_f32_bf16 v42, v225, v10, v9
    v_min_u32_e64 v5, 2, v1
    v_dot2_f32_bf16 v43, v225, v12, v9
    v_and_b32_e64 v194, 48, v1
    v_dot2_f32_bf16 v44, v226, v10, v9
    v_dot2_f32_bf16 v45, v226, v12, v9
    v_dot2_f32_bf16 v46, v227, v10, v9
    v_add_u32_e64 v195, s88, v194
    v_dot2_f32_bf16 v47, v227, v12, v9
    v_lshlrev_b32_e64 v5, 10, v5
    v_dot2_f32_bf16 v80, v228, v10, v9
    v_dot2_f32_bf16 v81, v228, v12, v9
    ds_write_b32 v193, v192
    v_dot2_f32_bf16 v82, v229, v10, v9
    v_dot2_f32_bf16 v83, v229, v12, v9
    v_dot2_f32_bf16 v84, v230, v10, v9
    s_mul_i32 s13, s7, 3072
    ds_read_b128 v[200:203], v195 offset:0
    v_dot2_f32_bf16 v85, v230, v12, v9
    v_dot2_f32_bf16 v86, v231, v10, v9
    v_dot2_f32_bf16 v87, v231, v12, v9
    ds_read_b128 v[204:207], v195 offset:64
    v_dot2_f32_bf16 v120, v232, v10, v9
    v_dot2_f32_bf16 v121, v232, v12, v9
    s_add_u32 s13, s13, 1179648
    v_dot2_f32_bf16 v122, v233, v10, v9
    ds_read_b128 v[208:211], v195 offset:128
    v_dot2_f32_bf16 v123, v233, v12, v9
    v_dot2_f32_bf16 v124, v234, v10, v9
    v_dot2_f32_bf16 v125, v234, v12, v9
    ds_read_b128 v[212:215], v195 offset:192
    v_dot2_f32_bf16 v126, v235, v10, v9
    buffer_load_dword v14, v5, s[32:35], s13 offen offset:384
    v_dot2_f32_bf16 v127, v235, v12, v9
    v_dot2_f32_bf16 v160, v236, v10, v9
    v_mov_b32 v193, 0xffffff00
    v_dot2_f32_bf16 v161, v236, v12, v9
    v_dot2_f32_bf16 v162, v237, v10, v9
    v_dot2_f32_bf16 v163, v237, v12, v9
    v_accvgpr_read_b32 v5, a210
    v_dot2_f32_bf16 v164, v238, v10, v9
    v_dot2_f32_bf16 v165, v238, v12, v9
    v_dot2_f32_bf16 v166, v239, v10, v9
    v_dot2_f32_bf16 v167, v239, v12, v9
    v_dot2_f32_bf16 v8, v240, s1, 0
    buffer_load_dwordx2 a[224:225], v5, s[28:31], s97 offen offset:0
    s_waitcnt vmcnt(26)
    s_waitcnt lgkmcnt(0)
    s_barrier
    s_nop 0
    v_dot2_f32_bf16 v9, v240, v240, 0
    v_dot2_f32_bf16 v8, v241, s1, v8
    v_dot2_f32_bf16 v9, v241, v241, v9
    ds_read_b64_tr_b16 v[216:217], v13 offset:12288
    v_dot2_f32_bf16 v8, v242, s1, v8
    v_dot2_f32_bf16 v9, v242, v242, v9
    buffer_load_dwordx2 a[226:227], v5, s[28:31], s97 offen offset:16
    v_dot2_f32_bf16 v8, v243, s1, v8
    ds_read_b64_tr_b16 v[218:219], v13 offset:12800
    v_dot2_f32_bf16 v9, v243, v243, v9
    v_dot2_f32_bf16 v8, v244, s1, v8
    v_dot2_f32_bf16 v9, v244, v244, v9
    v_dot2_f32_bf16 v8, v245, s1, v8
    buffer_load_dwordx2 a[228:229], v5, s[28:31], s97 offen offset:32
    ds_read_b64_tr_b16 v[220:221], v13 offset:28672
    v_dot2_f32_bf16 v9, v245, v245, v9
    v_dot2_f32_bf16 v8, v246, s1, v8
    v_dot2_f32_bf16 v9, v246, v246, v9
    ds_read_b64_tr_b16 v[222:223], v13 offset:29184
    v_dot2_f32_bf16 v8, v247, s1, v8
    v_dot2_f32_bf16 v9, v247, v247, v9
    buffer_load_dwordx2 a[230:231], v5, s[28:31], s97 offen offset:48
    v_dot2_f32_bf16 v8, v248, s1, v8
    ds_read_b64_tr_b16 v[224:225], v13 offset:45056
    v_dot2_f32_bf16 v9, v248, v248, v9
    v_dot2_f32_bf16 v8, v249, s1, v8
    v_dot2_f32_bf16 v9, v249, v249, v9
    v_dot2_f32_bf16 v8, v250, s1, v8
    ds_read_b64_tr_b16 v[226:227], v13 offset:45568
    v_dot2_f32_bf16 v9, v250, v250, v9
    v_dot2_f32_bf16 v8, v251, s1, v8
    v_dot2_f32_bf16 v9, v251, v251, v9
    ds_read_b64_tr_b16 v[228:229], v13 offset:61440
    v_dot2_f32_bf16 v8, v252, s1, v8
    v_dot2_f32_bf16 v9, v252, v252, v9
    v_dot2_f32_bf16 v8, v253, s1, v8
    ds_read_b64_tr_b16 v[230:231], v13 offset:61952
    v_dot2_f32_bf16 v9, v253, v253, v9
    v_dot2_f32_bf16 v8, v254, s1, v8
    v_dot2_f32_bf16 v9, v254, v254, v9
    v_dot2_f32_bf16 v8, v255, s1, v8
    v_dot2_f32_bf16 v9, v255, v255, v9
    s_nop 1
    v_add_f32_dpp v8, v8, v8 row_ror:8 row_mask:0xf bank_mask:0xf
    v_add_f32_dpp v9, v9, v9 row_ror:8 row_mask:0xf bank_mask:0xf
    s_nop 0
    v_add_f32_dpp v8, v8, v8 row_ror:4 row_mask:0xf bank_mask:0xf
    v_add_f32_dpp v9, v9, v9 row_ror:4 row_mask:0xf bank_mask:0xf
    s_nop 0
    v_add_f32_dpp v8, v8, v8 row_ror:2 row_mask:0xf bank_mask:0xf
    v_add_f32_dpp v9, v9, v9 row_ror:2 row_mask:0xf bank_mask:0xf
    s_nop 0
    v_add_f32_dpp v8, v8, v8 row_ror:1 row_mask:0xf bank_mask:0xf
    v_add_f32_dpp v9, v9, v9 row_ror:1 row_mask:0xf bank_mask:0xf
    v_mul_f32 v8, 0x3b000000, v8
    v_mul_f32 v9, 0x3b000000, v9
    v_fma_f32 v9, -v8, v8, v9
    s_waitcnt lgkmcnt(6)
    v_mfma_f32_16x16x32_bf16 v[196:199], v[216:219], v[200:203], 0
    v_max_f32 v9, 0, v9
    v_add_f32 v9, 0x3727c5ac, v9
    v_rsq_f32 v10, v9
    s_nop 0
    v_cvt_pk_bf16_f32 v10, v10, 0
    v_lshlrev_b32 v12, 16, v10
    s_waitcnt lgkmcnt(4)
    v_mfma_f32_16x16x32_bf16 v[196:199], v[220:223], v[204:207], v[196:199]
    v_mul_f32_e64 v9, -v8, v12
    v_dot2_f32_bf16 v48, v240, v10, v9
    v_dot2_f32_bf16 v49, v240, v12, v9
    v_dot2_f32_bf16 v50, v241, v10, v9
    v_dot2_f32_bf16 v51, v241, v12, v9
    s_waitcnt lgkmcnt(2)
    v_mfma_f32_16x16x32_bf16 v[196:199], v[224:227], v[208:211], v[196:199]
    v_dot2_f32_bf16 v52, v242, v10, v9
    v_dot2_f32_bf16 v53, v242, v12, v9
    v_dot2_f32_bf16 v54, v243, v10, v9
    v_dot2_f32_bf16 v55, v243, v12, v9
    v_dot2_f32_bf16 v88, v244, v10, v9
    s_waitcnt lgkmcnt(0)
    v_mfma_f32_16x16x32_bf16 v[196:199], v[228:231], v[212:215], v[196:199]
    v_dot2_f32_bf16 v89, v244, v12, v9
    v_dot2_f32_bf16 v90, v245, v10, v9
    v_dot2_f32_bf16 v91, v245, v12, v9
    v_dot2_f32_bf16 v92, v246, v10, v9
    v_dot2_f32_bf16 v93, v246, v12, v9
    v_dot2_f32_bf16 v94, v247, v10, v9
    v_dot2_f32_bf16 v95, v247, v12, v9
    v_dot2_f32_bf16 v128, v248, v10, v9
    v_dot2_f32_bf16 v129, v248, v12, v9
    v_dot2_f32_bf16 v130, v249, v10, v9
    v_dot2_f32_bf16 v131, v249, v12, v9
    v_dot2_f32_bf16 v132, v250, v10, v9
    v_dot2_f32_bf16 v133, v250, v12, v9
    v_dot2_f32_bf16 v134, v251, v10, v9
    v_dot2_f32_bf16 v135, v251, v12, v9
    v_dot2_f32_bf16 v168, v252, v10, v9
    v_and_or_b32 v196, v196, v193, s80
    v_dot2_f32_bf16 v169, v252, v12, v9
    v_and_or_b32 v197, v197, v193, s81
    v_dot2_f32_bf16 v170, v253, v10, v9
    v_dot2_f32_bf16 v171, v253, v12, v9
    v_and_or_b32 v198, v198, v193, s82
    v_dot2_f32_bf16 v172, v254, v10, v9
    v_and_or_b32 v199, v199, v193, s83
    v_dot2_f32_bf16 v173, v254, v12, v9
    v_dot2_f32_bf16 v174, v255, v10, v9
    s_mov_b32 exec_lo, 0x00010001
    s_mov_b32 exec_hi, 0x00010001
    buffer_store_dwordx4 v[196:199], v194, s[64:67], s25 offen sc1
    s_mov_b64 exec, -1
    s_nop 0
    v_dot2_f32_bf16 v175, v255, v12, v9
    v_accvgpr_read_b32 v248, a216
    v_accvgpr_read_b32 v249, a215
    v_accvgpr_read_b32 v250, a217
    v_accvgpr_read_b32 v8, a218
    v_add_u32 v12, 81920, v13
    v_add_u32 v13, 131072, v13
    v_xor_b32_e64 v9, 64, v8
    v_add_u32 v10, 65536, v8
    v_add_u32 v11, 65536, v9
    v_add_u32 v251, 155648, v4
    s_cmp_ge_u32 s68, 2
    s_cselect_b32 s88, 1.0, 0
    s_mov_b32 s96, 0
    s_mov_b32 s100, 0x0c0c0400
    s_mov_b32 s101, 0x04000c0c
L_mchk_7:
    s_waitcnt vmcnt(16)
    v_perm_b32 v241, v177, v176, s100
    v_perm_b32 v242, v179, v178, s101
    v_bitop3_b32 v240, v241, v242, s75 bitop3:0x56
    s_waitcnt vmcnt(15)
    v_perm_b32 v241, v181, v180, s100
    v_perm_b32 v242, v183, v182, s101
    v_bitop3_b32 v241, v241, v242, s75 bitop3:0x56
    v_or_b32 v240, v240, v241
    s_waitcnt vmcnt(14)
    v_perm_b32 v241, v185, v184, s100
    v_perm_b32 v242, v187, v186, s101
    v_bitop3_b32 v241, v241, v242, s75 bitop3:0x56
    v_or_b32 v240, v240, v241
    s_waitcnt vmcnt(13)
    v_perm_b32 v241, v189, v188, s100
    v_perm_b32 v242, v191, v190, s101
    v_bitop3_b32 v241, v241, v242, s75 bitop3:0x56
    v_or_b32 v240, v240, v241
    v_cmp_ne_u32 vcc, 0, v240
    s_cbranch_vccnz L_mretry_8
L_mchk_7_ok:
    s_mov_b32 s100, 0xffffff00
    v_min_u32 v5, 3, v1
    v_lshlrev_b32 v5, 7, v5
    s_lshl_b32 s13, s69, 7
    s_add_u32 s13, s13, s7
    s_lshl_b32 s13, s13, 9
    buffer_load_dword v14, v5, s[36:39], s13 offen
    v_and_b32 v176, s100, v176
    v_and_b32 v177, s100, v177
    v_and_b32 v178, s100, v178
    v_and_b32 v179, s100, v179
    v_and_b32 v180, s100, v180
    v_and_b32 v181, s100, v181
    v_and_b32 v182, s100, v182
    v_min_u32 v5, 3, v1
    v_lshlrev_b32 v5, 10, v5
    s_lshl_b32 s13, s7, 12
    buffer_load_dword v14, v5, s[36:39], s13 offen offset:384
    v_and_b32 v183, s100, v183
    v_and_b32 v184, s100, v184
    v_and_b32 v185, s100, v185
    v_and_b32 v186, s100, v186
    v_and_b32 v187, s100, v187
    v_and_b32 v188, s100, v188
    v_and_b32 v189, s100, v189
    v_and_b32 v190, s100, v190
    v_min_u32 v5, 21, v1
    v_lshlrev_b32 v5, 7, v5
    s_lshl_b32 s13, s21, 7
    s_add_u32 s13, s13, s7
    s_mul_i32 s13, s13, 2752
    buffer_load_dword v14, v5, s[40:43], s13 offen
    v_and_b32 v191, s100, v191
    v_pk_add_f32 v[176:177], v[176:177], v[180:181]
    v_pk_add_f32 v[184:185], v[184:185], v[188:189]
    v_pk_add_f32 v[178:179], v[178:179], v[182:183]
    v_pk_add_f32 v[186:187], v[186:187], v[190:191]
    v_pk_add_f32 v[176:177], v[176:177], v[184:185]
    v_pk_add_f32 v[178:179], v[178:179], v[186:187]
    v_cvt_pk_bf16_f32 v180, v176, v177
    buffer_load_dword v14, v5, s[44:47], s13 offen
    v_cvt_pk_bf16_f32 v181, v178, v179
    v_lshlrev_b32 v176, 16, v180
    v_and_b32 v177, s3, v180
    v_lshlrev_b32 v178, 16, v181
    v_and_b32 v179, s3, v181
    v_add_f32 v176, s88, v176
    v_add_f32 v177, s88, v177
    v_add_f32 v178, s88, v178
    v_min_u32 v5, 11, v1
    v_lshlrev_b32 v5, 7, v5
    s_lshl_b32 s13, s69, 7
    s_add_u32 s13, s13, s7
    s_mul_i32 s13, s13, 1376
    buffer_load_dword v14, v5, s[48:51], s13 offen
    v_add_f32 v179, s88, v179
    v_cvt_pk_bf16_f32 v180, v176, v177
    v_cvt_pk_bf16_f32 v181, v178, v179
    v_lshlrev_b32 v176, 16, v180
    v_and_b32 v177, s3, v180
    v_lshlrev_b32 v178, 16, v181
    v_and_b32 v179, s3, v181
    ds_write_b128 v251, v[176:179]
    s_waitcnt lgkmcnt(0)
    s_barrier
    ds_read_b128 v[176:179], v250 offset:0
    ds_read_b128 v[184:187], v250 offset:2048
    ds_read_b128 v[180:183], v250 offset:16
    ds_read_b128 v[188:191], v250 offset:2064
    ds_read_b128 v[192:195], v250 offset:512
    ds_read_b128 v[200:203], v250 offset:2560
    ds_read_b128 v[196:199], v250 offset:528
    ds_read_b128 v[204:207], v250 offset:2576
    ds_read_b128 v[208:211], v250 offset:1024
    ds_read_b128 v[216:219], v250 offset:3072
    ds_read_b128 v[212:215], v250 offset:1040
    ds_read_b128 v[220:223], v250 offset:3088
    ds_read_b128 v[224:227], v250 offset:1536
    ds_read_b128 v[232:235], v250 offset:3584
    ds_read_b128 v[228:231], v250 offset:1552
    ds_read_b128 v[236:239], v250 offset:3600
    s_waitcnt lgkmcnt(14)
    v_pk_fma_f32 v[16:17], v[16:17], v[184:185], v[176:177]
    v_pk_fma_f32 v[18:19], v[18:19], v[186:187], v[178:179]
    v_accvgpr_read_b32 v5, a211
    buffer_load_dword v14, v5, s[64:67], s74 offen
    s_waitcnt lgkmcnt(12)
    v_pk_fma_f32 v[20:21], v[20:21], v[188:189], v[180:181]
    v_pk_fma_f32 v[22:23], v[22:23], v[190:191], v[182:183]
    v_cvt_pk_bf16_f32 v16, v16, v17
    v_cvt_pk_bf16_f32 v17, v18, v19
    v_cvt_pk_bf16_f32 v18, v20, v21
    v_cvt_pk_bf16_f32 v19, v22, v23
    ds_write_b128 v248, v[16:19] offset:0
    v_pk_fma_f32 v[24:25], v[24:25], v[184:185], v[176:177]
    v_pk_fma_f32 v[26:27], v[26:27], v[186:187], v[178:179]
    v_and_b32 v5, 7, v1
    v_lshlrev_b32 v5, 7, v5
    buffer_load_dword v14, v5, s[60:63], s9 offen
    v_pk_fma_f32 v[28:29], v[28:29], v[188:189], v[180:181]
    v_pk_fma_f32 v[30:31], v[30:31], v[190:191], v[182:183]
    v_cvt_pk_bf16_f32 v24, v24, v25
    v_cvt_pk_bf16_f32 v25, v26, v27
    v_cvt_pk_bf16_f32 v26, v28, v29
    v_cvt_pk_bf16_f32 v27, v30, v31
    ds_write_b128 v249, v[24:27] offset:16384
    v_pk_fma_f32 v[32:33], v[32:33], v[184:185], v[176:177]
    v_pk_fma_f32 v[34:35], v[34:35], v[186:187], v[178:179]
    v_pk_fma_f32 v[36:37], v[36:37], v[188:189], v[180:181]
    v_pk_fma_f32 v[38:39], v[38:39], v[190:191], v[182:183]
    v_cvt_pk_bf16_f32 v32, v32, v33
    v_cvt_pk_bf16_f32 v33, v34, v35
    v_cvt_pk_bf16_f32 v34, v36, v37
    v_cvt_pk_bf16_f32 v35, v38, v39
    ds_write_b128 v249, v[32:35] offset:16512
    v_pk_fma_f32 v[40:41], v[40:41], v[184:185], v[176:177]
    v_pk_fma_f32 v[42:43], v[42:43], v[186:187], v[178:179]
    v_pk_fma_f32 v[44:45], v[44:45], v[188:189], v[180:181]
    v_pk_fma_f32 v[46:47], v[46:47], v[190:191], v[182:183]
    v_cvt_pk_bf16_f32 v40, v40, v41
    v_cvt_pk_bf16_f32 v41, v42, v43
    v_cvt_pk_bf16_f32 v42, v44, v45
    v_cvt_pk_bf16_f32 v43, v46, v47
    ds_write_b128 v249, v[40:43] offset:49152
    v_pk_fma_f32 v[48:49], v[48:49], v[184:185], v[176:177]
    v_pk_fma_f32 v[50:51], v[50:51], v[186:187], v[178:179]
    s_add_u32 s13, s9, 32768
    buffer_load_dword v14, v5, s[60:63], s13 offen
    v_pk_fma_f32 v[52:53], v[52:53], v[188:189], v[180:181]
    v_pk_fma_f32 v[54:55], v[54:55], v[190:191], v[182:183]
    v_cvt_pk_bf16_f32 v48, v48, v49
    v_cvt_pk_bf16_f32 v49, v50, v51
    v_cvt_pk_bf16_f32 v50, v52, v53
    v_cvt_pk_bf16_f32 v51, v54, v55
    ds_write_b128 v249, v[48:51] offset:49280
    s_waitcnt lgkmcnt(15)
    v_pk_fma_f32 v[56:57], v[56:57], v[200:201], v[192:193]
    v_pk_fma_f32 v[58:59], v[58:59], v[202:203], v[194:195]
    s_waitcnt lgkmcnt(13)
    v_pk_fma_f32 v[60:61], v[60:61], v[204:205], v[196:197]
    v_pk_fma_f32 v[62:63], v[62:63], v[206:207], v[198:199]
    v_cvt_pk_bf16_f32 v56, v56, v57
    v_cvt_pk_bf16_f32 v57, v58, v59
    v_cvt_pk_bf16_f32 v58, v60, v61
    v_cvt_pk_bf16_f32 v59, v62, v63
    ds_write_b128 v248, v[56:59] offset:4096
    v_pk_fma_f32 v[64:65], v[64:65], v[200:201], v[192:193]
    v_pk_fma_f32 v[66:67], v[66:67], v[202:203], v[194:195]
    v_pk_fma_f32 v[68:69], v[68:69], v[204:205], v[196:197]
    v_pk_fma_f32 v[70:71], v[70:71], v[206:207], v[198:199]
    v_cvt_pk_bf16_f32 v64, v64, v65
    v_cvt_pk_bf16_f32 v65, v66, v67
    v_cvt_pk_bf16_f32 v66, v68, v69
    v_cvt_pk_bf16_f32 v67, v70, v71
    ds_write_b128 v249, v[64:67] offset:20480
    v_pk_fma_f32 v[72:73], v[72:73], v[200:201], v[192:193]
    v_pk_fma_f32 v[74:75], v[74:75], v[202:203], v[194:195]
    v_pk_fma_f32 v[76:77], v[76:77], v[204:205], v[196:197]
    v_pk_fma_f32 v[78:79], v[78:79], v[206:207], v[198:199]
    v_cvt_pk_bf16_f32 v72, v72, v73
    v_cvt_pk_bf16_f32 v73, v74, v75
    v_cvt_pk_bf16_f32 v74, v76, v77
    v_cvt_pk_bf16_f32 v75, v78, v79
    ds_write_b128 v249, v[72:75] offset:20608
    v_pk_fma_f32 v[80:81], v[80:81], v[200:201], v[192:193]
    v_pk_fma_f32 v[82:83], v[82:83], v[202:203], v[194:195]
    v_pk_fma_f32 v[84:85], v[84:85], v[204:205], v[196:197]
    v_pk_fma_f32 v[86:87], v[86:87], v[206:207], v[198:199]
    v_cvt_pk_bf16_f32 v80, v80, v81
    v_cvt_pk_bf16_f32 v81, v82, v83
    v_cvt_pk_bf16_f32 v82, v84, v85
    v_cvt_pk_bf16_f32 v83, v86, v87
    ds_write_b128 v249, v[80:83] offset:53248
    v_pk_fma_f32 v[88:89], v[88:89], v[200:201], v[192:193]
    v_pk_fma_f32 v[90:91], v[90:91], v[202:203], v[194:195]
    v_pk_fma_f32 v[92:93], v[92:93], v[204:205], v[196:197]
    v_pk_fma_f32 v[94:95], v[94:95], v[206:207], v[198:199]
    v_cvt_pk_bf16_f32 v88, v88, v89
    v_cvt_pk_bf16_f32 v89, v90, v91
    v_cvt_pk_bf16_f32 v90, v92, v93
    v_cvt_pk_bf16_f32 v91, v94, v95
    ds_write_b128 v249, v[88:91] offset:53376
    s_waitcnt lgkmcnt(15)
    v_pk_fma_f32 v[96:97], v[96:97], v[216:217], v[208:209]
    v_pk_fma_f32 v[98:99], v[98:99], v[218:219], v[210:211]
    s_waitcnt lgkmcnt(14)
    v_pk_fma_f32 v[100:101], v[100:101], v[220:221], v[212:213]
    v_pk_fma_f32 v[102:103], v[102:103], v[222:223], v[214:215]
    v_cvt_pk_bf16_f32 v96, v96, v97
    v_cvt_pk_bf16_f32 v97, v98, v99
    v_cvt_pk_bf16_f32 v98, v100, v101
    v_cvt_pk_bf16_f32 v99, v102, v103
    ds_write_b128 v248, v[96:99] offset:8192
    v_pk_fma_f32 v[104:105], v[104:105], v[216:217], v[208:209]
    v_pk_fma_f32 v[106:107], v[106:107], v[218:219], v[210:211]
    v_pk_fma_f32 v[108:109], v[108:109], v[220:221], v[212:213]
    v_pk_fma_f32 v[110:111], v[110:111], v[222:223], v[214:215]
    v_cvt_pk_bf16_f32 v104, v104, v105
    v_cvt_pk_bf16_f32 v105, v106, v107
    v_cvt_pk_bf16_f32 v106, v108, v109
    v_cvt_pk_bf16_f32 v107, v110, v111
    ds_write_b128 v249, v[104:107] offset:24576
    v_pk_fma_f32 v[112:113], v[112:113], v[216:217], v[208:209]
    v_pk_fma_f32 v[114:115], v[114:115], v[218:219], v[210:211]
    v_pk_fma_f32 v[116:117], v[116:117], v[220:221], v[212:213]
    v_pk_fma_f32 v[118:119], v[118:119], v[222:223], v[214:215]
    v_cvt_pk_bf16_f32 v112, v112, v113
    v_cvt_pk_bf16_f32 v113, v114, v115
    v_cvt_pk_bf16_f32 v114, v116, v117
    v_cvt_pk_bf16_f32 v115, v118, v119
    ds_write_b128 v249, v[112:115] offset:24704
    v_pk_fma_f32 v[120:121], v[120:121], v[216:217], v[208:209]
    v_pk_fma_f32 v[122:123], v[122:123], v[218:219], v[210:211]
    v_pk_fma_f32 v[124:125], v[124:125], v[220:221], v[212:213]
    v_pk_fma_f32 v[126:127], v[126:127], v[222:223], v[214:215]
    v_cvt_pk_bf16_f32 v120, v120, v121
    v_cvt_pk_bf16_f32 v121, v122, v123
    v_cvt_pk_bf16_f32 v122, v124, v125
    v_cvt_pk_bf16_f32 v123, v126, v127
    ds_write_b128 v249, v[120:123] offset:57344
    v_pk_fma_f32 v[128:129], v[128:129], v[216:217], v[208:209]
    v_pk_fma_f32 v[130:131], v[130:131], v[218:219], v[210:211]
    v_pk_fma_f32 v[132:133], v[132:133], v[220:221], v[212:213]
    v_pk_fma_f32 v[134:135], v[134:135], v[222:223], v[214:215]
    v_cvt_pk_bf16_f32 v128, v128, v129
    v_cvt_pk_bf16_f32 v129, v130, v131
    v_cvt_pk_bf16_f32 v130, v132, v133
    v_cvt_pk_bf16_f32 v131, v134, v135
    ds_write_b128 v249, v[128:131] offset:57472
    s_waitcnt lgkmcnt(15)
    v_pk_fma_f32 v[136:137], v[136:137], v[232:233], v[224:225]
    v_pk_fma_f32 v[138:139], v[138:139], v[234:235], v[226:227]
    s_waitcnt lgkmcnt(15)
    v_pk_fma_f32 v[140:141], v[140:141], v[236:237], v[228:229]
    v_pk_fma_f32 v[142:143], v[142:143], v[238:239], v[230:231]
    v_cvt_pk_bf16_f32 v136, v136, v137
    v_cvt_pk_bf16_f32 v137, v138, v139
    v_cvt_pk_bf16_f32 v138, v140, v141
    v_cvt_pk_bf16_f32 v139, v142, v143
    ds_write_b128 v248, v[136:139] offset:12288
    v_pk_fma_f32 v[144:145], v[144:145], v[232:233], v[224:225]
    v_pk_fma_f32 v[146:147], v[146:147], v[234:235], v[226:227]
    v_pk_fma_f32 v[148:149], v[148:149], v[236:237], v[228:229]
    v_pk_fma_f32 v[150:151], v[150:151], v[238:239], v[230:231]
    v_cvt_pk_bf16_f32 v144, v144, v145
    v_cvt_pk_bf16_f32 v145, v146, v147
    v_cvt_pk_bf16_f32 v146, v148, v149
    v_cvt_pk_bf16_f32 v147, v150, v151
    ds_write_b128 v249, v[144:147] offset:28672
    v_pk_fma_f32 v[152:153], v[152:153], v[232:233], v[224:225]
    v_pk_fma_f32 v[154:155], v[154:155], v[234:235], v[226:227]
    v_pk_fma_f32 v[156:157], v[156:157], v[236:237], v[228:229]
    v_pk_fma_f32 v[158:159], v[158:159], v[238:239], v[230:231]
    v_cvt_pk_bf16_f32 v152, v152, v153
    v_cvt_pk_bf16_f32 v153, v154, v155
    v_cvt_pk_bf16_f32 v154, v156, v157
    v_cvt_pk_bf16_f32 v155, v158, v159
    ds_write_b128 v249, v[152:155] offset:28800
    v_pk_fma_f32 v[160:161], v[160:161], v[232:233], v[224:225]
    v_pk_fma_f32 v[162:163], v[162:163], v[234:235], v[226:227]
    v_pk_fma_f32 v[164:165], v[164:165], v[236:237], v[228:229]
    v_pk_fma_f32 v[166:167], v[166:167], v[238:239], v[230:231]
    v_cvt_pk_bf16_f32 v160, v160, v161
    v_cvt_pk_bf16_f32 v161, v162, v163
    v_cvt_pk_bf16_f32 v162, v164, v165
    v_cvt_pk_bf16_f32 v163, v166, v167
    ds_write_b128 v249, v[160:163] offset:61440
    v_pk_fma_f32 v[168:169], v[168:169], v[232:233], v[224:225]
    v_pk_fma_f32 v[170:171], v[170:171], v[234:235], v[226:227]
    v_pk_fma_f32 v[172:173], v[172:173], v[236:237], v[228:229]
    v_pk_fma_f32 v[174:175], v[174:175], v[238:239], v[230:231]
    v_cvt_pk_bf16_f32 v168, v168, v169
    v_cvt_pk_bf16_f32 v169, v170, v171
    v_cvt_pk_bf16_f32 v170, v172, v173
    v_cvt_pk_bf16_f32 v171, v174, v175
    ds_write_b128 v249, v[168:171] offset:61568
    s_waitcnt lgkmcnt(0)
    s_barrier
    ds_read_b64_tr_b16 a[4:5], v12 offset:8192
    ds_read_b64_tr_b16 a[6:7], v12 offset:8704
    ds_read_b64_tr_b16 a[8:9], v12 offset:16384
    ds_read_b64_tr_b16 a[10:11], v12 offset:16896
    ds_read_b64_tr_b16 a[0:1], v12 offset:0
    ds_read_b64_tr_b16 a[2:3], v12 offset:512
    ds_read_b128 v[16:19], v8 offset:0
    ds_read_b128 v[20:23], v8 offset:16384
    ds_read_b128 v[24:27], v8 offset:32768
    ds_read_b128 v[28:31], v8 offset:49152
    ds_read_b128 v[32:35], v10 offset:0
    ds_read_b64_tr_b16 a[16:17], v12 offset:12288
    ds_read_b64_tr_b16 a[18:19], v12 offset:12800
    ds_read_b64_tr_b16 a[20:21], v12 offset:20480
    ds_read_b64_tr_b16 a[22:23], v12 offset:20992
    ds_read_b64_tr_b16 a[12:13], v12 offset:4096
    ds_read_b64_tr_b16 a[14:15], v12 offset:4608
    s_waitcnt lgkmcnt(10)
    v_mfma_f32_16x16x32_bf16 v[72:75], a[4:7], v[16:19], 0
    ds_read_b128 v[36:39], v9 offset:1024
    v_mfma_f32_16x16x32_bf16 v[92:95], v[16:19], a[8:11], 0
    s_waitcnt lgkmcnt(10)
    v_mfma_f32_16x16x32_bf16 v[76:79], a[4:7], v[20:23], 0
    ds_read_b128 v[40:43], v9 offset:17408
    v_mfma_f32_16x16x32_bf16 v[96:99], v[20:23], a[8:11], 0
    s_waitcnt lgkmcnt(2)
    s_barrier
    ds_read_b128 v[44:47], v9 offset:33792
    v_mfma_f32_16x16x32_bf16 v[56:59], a[0:3], v[20:23], 0
    ds_read_b64_tr_b16 a[28:29], v12 offset:32768
    v_accvgpr_read_b32 v4, a214
    s_add_u32 s4, s17, 589824
    v_mfma_f32_16x16x32_bf16 v[80:83], a[4:7], v[24:27], 0
    ds_read_b64_tr_b16 a[30:31], v12 offset:33280
    s_add_u32 m0, s5, 81920
    v_mfma_f32_16x16x32_bf16 v[100:103], v[24:27], a[8:11], 0
    buffer_load_dwordx4 v6, s[32:35], s4 offen lds
    v_mfma_f32_16x16x32_bf16 v[60:63], a[0:3], v[24:27], 0
    ds_read_b128 v[48:51], v9 offset:50176
    s_add_u32 m0, s5, 82944
    v_mfma_f32_16x16x32_bf16 v[84:87], a[4:7], v[28:31], 0
    ds_read_b64_tr_b16 a[32:33], v12 offset:40960
    v_mfma_f32_16x16x32_bf16 v[104:107], v[28:31], a[8:11], 0
    ds_read_b64_tr_b16 a[34:35], v12 offset:41472
    v_mfma_f32_16x16x32_bf16 v[64:67], a[0:3], v[28:31], 0
    ds_read_b128 v[52:55], v11 offset:1024
    v_accvgpr_read_b32 v208, a192
    v_mfma_f32_16x16x32_bf16 v[88:91], a[4:7], v[32:35], 0
    buffer_load_dwordx4 v7, s[32:35], s4 offen lds
    v_mfma_f32_16x16x32_bf16 v[108:111], v[32:35], a[8:11], 0
    ds_read_b64_tr_b16 a[24:25], v12 offset:24576
    s_add_u32 m0, s5, 89088
    v_mfma_f32_16x16x32_bf16 v[68:71], a[0:3], v[32:35], 0
    ds_read_b64_tr_b16 a[26:27], v12 offset:25088
    s_waitcnt lgkmcnt(5)
    v_mfma_f32_16x16x32_bf16 v[72:75], a[16:19], v[36:39], v[72:75]
    ds_read_b128 v[16:19], v8 offset:2048
    v_mfma_f32_16x16x32_bf16 v[92:95], v[36:39], a[20:23], v[92:95]
    ds_read_b64_tr_b16 a[40:41], v12 offset:36864
    v_mfma_f32_16x16x32_bf16 v[76:79], a[16:19], v[40:43], v[76:79]
    buffer_load_dwordx4 v6, s[32:35], s4 offen offset:1024 lds
    v_accvgpr_read_b32 v209, a193
    v_mfma_f32_16x16x32_bf16 v[96:99], v[40:43], a[20:23], v[96:99]
    ds_read_b128 v[20:23], v8 offset:18432
    s_add_u32 m0, s5, 90112
    v_mfma_f32_16x16x32_bf16 v[56:59], a[12:15], v[40:43], v[56:59]
    ds_read_b64_tr_b16 a[42:43], v12 offset:37376
    v_mfma_f32_16x16x32_bf16 v[80:83], a[16:19], v[44:47], v[80:83]
    ds_read_b64_tr_b16 a[44:45], v12 offset:45056
    v_mfma_f32_16x16x32_bf16 v[100:103], v[44:47], a[20:23], v[100:103]
    buffer_load_dwordx4 v7, s[32:35], s4 offen offset:1024 lds
    v_mfma_f32_16x16x32_bf16 v[60:63], a[12:15], v[44:47], v[60:63]
    ds_read_b128 v[24:27], v8 offset:34816
    s_add_u32 m0, s5, 96256
    v_mfma_f32_16x16x32_bf16 v[84:87], a[16:19], v[48:51], v[84:87]
    ds_read_b64_tr_b16 a[46:47], v12 offset:45568
    v_mfma_f32_16x16x32_bf16 v[104:107], v[48:51], a[20:23], v[104:107]
    ds_read_b64_tr_b16 a[36:37], v12 offset:28672
    v_accvgpr_read_b32 v210, a194
    v_mfma_f32_16x16x32_bf16 v[64:67], a[12:15], v[48:51], v[64:67]
    ds_read_b64_tr_b16 a[38:39], v12 offset:29184
    s_waitcnt lgkmcnt(5)
    v_mfma_f32_16x16x32_bf16 v[88:91], a[16:19], v[52:55], v[88:91]
    buffer_load_dwordx4 v6, s[32:35], s4 offen offset:2048 lds
    v_mfma_f32_16x16x32_bf16 v[108:111], v[52:55], a[20:23], v[108:111]
    ds_read_b128 v[28:31], v8 offset:51200
    s_add_u32 m0, s5, 97280
    v_mfma_f32_16x16x32_bf16 v[68:71], a[12:15], v[52:55], v[68:71]
    ds_read_b128 v[32:35], v10 offset:2048
    v_mfma_f32_16x16x32_bf16 v[72:75], a[28:31], v[16:19], v[72:75]
    ds_read_b128 v[36:39], v9 offset:3072
    v_mfma_f32_16x16x32_bf16 v[92:95], v[16:19], a[32:35], v[92:95]
    buffer_load_dwordx4 v7, s[32:35], s4 offen offset:2048 lds
    v_accvgpr_read_b32 v211, a195
    v_mfma_f32_16x16x32_bf16 v[76:79], a[28:31], v[20:23], v[76:79]
    ds_read_b128 v[40:43], v9 offset:19456
    v_mfma_f32_16x16x32_bf16 v[96:99], v[20:23], a[32:35], v[96:99]
    s_waitcnt vmcnt(20) lgkmcnt(4)
    s_barrier
    ds_read_b128 v[44:47], v9 offset:35840
    v_mfma_f32_16x16x32_bf16 v[56:59], a[24:27], v[20:23], v[56:59]
    ds_read_b64_tr_b16 a[52:53], v13 offset:8192
    s_add_u32 s4, s17, 786432
    v_mfma_f32_16x16x32_bf16 v[80:83], a[28:31], v[24:27], v[80:83]
    ds_read_b64_tr_b16 a[54:55], v13 offset:8704
    s_add_u32 m0, s5, 106496
    v_mfma_f32_16x16x32_bf16 v[100:103], v[24:27], a[32:35], v[100:103]
    buffer_load_dwordx4 v6, s[32:35], s4 offen lds
    v_mfma_f32_16x16x32_bf16 v[60:63], a[24:27], v[24:27], v[60:63]
    ds_read_b128 v[48:51], v9 offset:52224
    s_add_u32 m0, s5, 107520
    s_waitcnt lgkmcnt(5)
    v_mfma_f32_16x16x32_bf16 v[84:87], a[28:31], v[28:31], v[84:87]
    ds_read_b64_tr_b16 a[56:57], v13 offset:16384
    v_accvgpr_read_b32 v212, a196
    v_mfma_f32_16x16x32_bf16 v[104:107], v[28:31], a[32:35], v[104:107]
    ds_read_b64_tr_b16 a[58:59], v13 offset:16896
    v_mfma_f32_16x16x32_bf16 v[64:67], a[24:27], v[28:31], v[64:67]
    ds_read_b128 v[52:55], v11 offset:3072
    v_mfma_f32_16x16x32_bf16 v[88:91], a[28:31], v[32:35], v[88:91]
    buffer_load_dwordx4 v7, s[32:35], s4 offen lds
    v_mfma_f32_16x16x32_bf16 v[108:111], v[32:35], a[32:35], v[108:111]
    ds_read_b64_tr_b16 a[48:49], v13 offset:0
    s_add_u32 m0, s5, 113664
    v_mfma_f32_16x16x32_bf16 v[68:71], a[24:27], v[32:35], v[68:71]
    ds_read_b64_tr_b16 a[50:51], v13 offset:512
    v_mfma_f32_16x16x32_bf16 v[72:75], a[40:43], v[36:39], v[72:75]
    ds_read_b128 v[16:19], v8 offset:4096
    v_accvgpr_read_b32 v213, a197
    v_mfma_f32_16x16x32_bf16 v[92:95], v[36:39], a[44:47], v[92:95]
    ds_read_b64_tr_b16 a[64:65], v13 offset:12288
    s_waitcnt lgkmcnt(5)
    v_mfma_f32_16x16x32_bf16 v[76:79], a[40:43], v[40:43], v[76:79]
    buffer_load_dwordx4 v6, s[32:35], s4 offen offset:1024 lds
    v_mfma_f32_16x16x32_bf16 v[96:99], v[40:43], a[44:47], v[96:99]
    ds_read_b128 v[20:23], v8 offset:20480
    s_add_u32 m0, s5, 114688
    v_mfma_f32_16x16x32_bf16 v[56:59], a[36:39], v[40:43], v[56:59]
    ds_read_b64_tr_b16 a[66:67], v13 offset:12800
    v_mfma_f32_16x16x32_bf16 v[80:83], a[40:43], v[44:47], v[80:83]
    ds_read_b64_tr_b16 a[68:69], v13 offset:20480
    v_mfma_f32_16x16x32_bf16 v[100:103], v[44:47], a[44:47], v[100:103]
    buffer_load_dwordx4 v7, s[32:35], s4 offen offset:1024 lds
    v_mfma_f32_16x16x32_bf16 v[60:63], a[36:39], v[44:47], v[60:63]
    ds_read_b128 v[24:27], v8 offset:36864
    v_accvgpr_read_b32 v214, a198
    s_add_u32 m0, s5, 120832
    v_mfma_f32_16x16x32_bf16 v[84:87], a[40:43], v[48:51], v[84:87]
    ds_read_b64_tr_b16 a[70:71], v13 offset:20992
    v_mfma_f32_16x16x32_bf16 v[104:107], v[48:51], a[44:47], v[104:107]
    ds_read_b64_tr_b16 a[60:61], v13 offset:4096
    v_mfma_f32_16x16x32_bf16 v[64:67], a[36:39], v[48:51], v[64:67]
    ds_read_b64_tr_b16 a[62:63], v13 offset:4608
    s_waitcnt lgkmcnt(5)
    v_mfma_f32_16x16x32_bf16 v[88:91], a[40:43], v[52:55], v[88:91]
    buffer_load_dwordx4 v6, s[32:35], s4 offen offset:2048 lds
    v_mfma_f32_16x16x32_bf16 v[108:111], v[52:55], a[44:47], v[108:111]
    ds_read_b128 v[28:31], v8 offset:53248
    s_add_u32 m0, s5, 121856
    v_mfma_f32_16x16x32_bf16 v[68:71], a[36:39], v[52:55], v[68:71]
    ds_read_b128 v[32:35], v10 offset:4096
    v_accvgpr_read_b32 v215, a199
    v_mfma_f32_16x16x32_bf16 v[72:75], a[52:55], v[16:19], v[72:75]
    ds_read_b128 v[36:39], v9 offset:5120
    v_mfma_f32_16x16x32_bf16 v[92:95], v[16:19], a[56:59], v[92:95]
    buffer_load_dwordx4 v7, s[32:35], s4 offen offset:2048 lds
    v_mfma_f32_16x16x32_bf16 v[76:79], a[52:55], v[20:23], v[76:79]
    ds_read_b128 v[40:43], v9 offset:21504
    v_mfma_f32_16x16x32_bf16 v[96:99], v[20:23], a[56:59], v[96:99]
    s_waitcnt vmcnt(6) lgkmcnt(4)
    s_barrier
    ds_read_b128 v[44:47], v9 offset:37888
    v_mfma_f32_16x16x32_bf16 v[56:59], a[48:51], v[20:23], v[56:59]
    ds_read_b64_tr_b16 a[76:77], v12 offset:8192
    s_add_u32 s4, s17, 983040
    v_mfma_f32_16x16x32_bf16 v[80:83], a[52:55], v[24:27], v[80:83]
    ds_read_b64_tr_b16 a[78:79], v12 offset:8704
    s_add_u32 m0, s5, 131072
    v_mfma_f32_16x16x32_bf16 v[100:103], v[24:27], a[56:59], v[100:103]
    buffer_load_dwordx4 v6, s[32:35], s4 offen lds
    v_accvgpr_read_b32 v216, a200
    v_mfma_f32_16x16x32_bf16 v[60:63], a[48:51], v[24:27], v[60:63]
    ds_read_b128 v[48:51], v9 offset:54272
    s_add_u32 m0, s5, 132096
    s_waitcnt lgkmcnt(4)
    v_mfma_f32_16x16x32_bf16 v[84:87], a[52:55], v[28:31], v[84:87]
    ds_read_b64_tr_b16 a[80:81], v12 offset:16384
    v_mfma_f32_16x16x32_bf16 v[104:107], v[28:31], a[56:59], v[104:107]
    ds_read_b64_tr_b16 a[82:83], v12 offset:16896
    v_mfma_f32_16x16x32_bf16 v[64:67], a[48:51], v[28:31], v[64:67]
    ds_read_b128 v[52:55], v11 offset:5120
    v_mfma_f32_16x16x32_bf16 v[88:91], a[52:55], v[32:35], v[88:91]
    buffer_load_dwordx4 v7, s[32:35], s4 offen lds
    v_mfma_f32_16x16x32_bf16 v[108:111], v[32:35], a[56:59], v[108:111]
    ds_read_b64_tr_b16 a[72:73], v12 offset:0
    v_accvgpr_read_b32 v217, a201
    s_add_u32 m0, s5, 138240
    v_mfma_f32_16x16x32_bf16 v[68:71], a[48:51], v[32:35], v[68:71]
    ds_read_b64_tr_b16 a[74:75], v12 offset:512
    v_mfma_f32_16x16x32_bf16 v[72:75], a[64:67], v[36:39], v[72:75]
    ds_read_b128 v[16:19], v8 offset:6144
    v_mfma_f32_16x16x32_bf16 v[92:95], v[36:39], a[68:71], v[92:95]
    ds_read_b64_tr_b16 a[88:89], v12 offset:12288
    v_mfma_f32_16x16x32_bf16 v[76:79], a[64:67], v[40:43], v[76:79]
    buffer_load_dwordx4 v6, s[32:35], s4 offen offset:1024 lds
    v_mfma_f32_16x16x32_bf16 v[96:99], v[40:43], a[68:71], v[96:99]
    ds_read_b128 v[20:23], v8 offset:22528
    s_add_u32 m0, s5, 139264
    v_mfma_f32_16x16x32_bf16 v[56:59], a[60:63], v[40:43], v[56:59]
    ds_read_b64_tr_b16 a[90:91], v12 offset:12800
    s_waitcnt lgkmcnt(5)
    v_mfma_f32_16x16x32_bf16 v[80:83], a[64:67], v[44:47], v[80:83]
    ds_read_b64_tr_b16 a[92:93], v12 offset:20480
    v_accvgpr_read_b32 v218, a202
    v_mfma_f32_16x16x32_bf16 v[100:103], v[44:47], a[68:71], v[100:103]
    buffer_load_dwordx4 v7, s[32:35], s4 offen offset:1024 lds
    v_mfma_f32_16x16x32_bf16 v[60:63], a[60:63], v[44:47], v[60:63]
    ds_read_b128 v[24:27], v8 offset:38912
    s_add_u32 m0, s5, 145408
    v_mfma_f32_16x16x32_bf16 v[84:87], a[64:67], v[48:51], v[84:87]
    ds_read_b64_tr_b16 a[94:95], v12 offset:20992
    v_mfma_f32_16x16x32_bf16 v[104:107], v[48:51], a[68:71], v[104:107]
    ds_read_b64_tr_b16 a[84:85], v12 offset:4096
    v_mfma_f32_16x16x32_bf16 v[64:67], a[60:63], v[48:51], v[64:67]
    ds_read_b64_tr_b16 a[86:87], v12 offset:4608
    v_mfma_f32_16x16x32_bf16 v[88:91], a[64:67], v[52:55], v[88:91]
    buffer_load_dwordx4 v6, s[32:35], s4 offen offset:2048 lds
    v_accvgpr_read_b32 v219, a203
    v_mfma_f32_16x16x32_bf16 v[108:111], v[52:55], a[68:71], v[108:111]
    ds_read_b128 v[28:31], v8 offset:55296
    s_add_u32 m0, s5, 146432
    v_mfma_f32_16x16x32_bf16 v[68:71], a[60:63], v[52:55], v[68:71]
    ds_read_b128 v[32:35], v10 offset:6144
    s_waitcnt lgkmcnt(5)
    v_mfma_f32_16x16x32_bf16 v[72:75], a[76:79], v[16:19], v[72:75]
    ds_read_b128 v[36:39], v9 offset:7168
    v_mfma_f32_16x16x32_bf16 v[92:95], v[16:19], a[80:83], v[92:95]
    buffer_load_dwordx4 v7, s[32:35], s4 offen offset:2048 lds
    v_mfma_f32_16x16x32_bf16 v[76:79], a[76:79], v[20:23], v[76:79]
    ds_read_b128 v[40:43], v9 offset:23552
    v_mfma_f32_16x16x32_bf16 v[96:99], v[20:23], a[80:83], v[96:99]
    s_waitcnt vmcnt(6) lgkmcnt(4)
    s_barrier
    ds_read_b128 v[44:47], v9 offset:39936
    v_mfma_f32_16x16x32_bf16 v[56:59], a[72:75], v[20:23], v[56:59]
    ds_read_b64_tr_b16 a[100:101], v12 offset:32768
    v_accvgpr_read_b32 v220, a204
    s_add_u32 s4, s17, 1179648
    v_mfma_f32_16x16x32_bf16 v[80:83], a[76:79], v[24:27], v[80:83]
    ds_read_b64_tr_b16 a[102:103], v12 offset:33280
    s_add_u32 m0, s5, 81920
    v_mfma_f32_16x16x32_bf16 v[100:103], v[24:27], a[80:83], v[100:103]
    buffer_load_dwordx4 v6, s[32:35], s4 offen lds
    v_mfma_f32_16x16x32_bf16 v[60:63], a[72:75], v[24:27], v[60:63]
    ds_read_b128 v[48:51], v9 offset:56320
    s_add_u32 m0, s5, 82944
    s_waitcnt lgkmcnt(4)
    v_mfma_f32_16x16x32_bf16 v[84:87], a[76:79], v[28:31], v[84:87]
    ds_read_b64_tr_b16 a[104:105], v12 offset:40960
    v_mfma_f32_16x16x32_bf16 v[104:107], v[28:31], a[80:83], v[104:107]
    ds_read_b64_tr_b16 a[106:107], v12 offset:41472
    v_mfma_f32_16x16x32_bf16 v[64:67], a[72:75], v[28:31], v[64:67]
    ds_read_b128 v[52:55], v11 offset:7168
    v_accvgpr_read_b32 v221, a205
    v_mfma_f32_16x16x32_bf16 v[88:91], a[76:79], v[32:35], v[88:91]
    buffer_load_dwordx4 v7, s[32:35], s4 offen lds
    v_mfma_f32_16x16x32_bf16 v[108:111], v[32:35], a[80:83], v[108:111]
    ds_read_b64_tr_b16 a[96:97], v12 offset:24576
    s_add_u32 m0, s5, 89088
    v_mfma_f32_16x16x32_bf16 v[68:71], a[72:75], v[32:35], v[68:71]
    ds_read_b64_tr_b16 a[98:99], v12 offset:25088
    v_mfma_f32_16x16x32_bf16 v[72:75], a[88:91], v[36:39], v[72:75]
    ds_read_b128 v[16:19], v8 offset:8192
    v_mfma_f32_16x16x32_bf16 v[92:95], v[36:39], a[92:95], v[92:95]
    ds_read_b64_tr_b16 a[112:113], v12 offset:36864
    v_mfma_f32_16x16x32_bf16 v[76:79], a[88:91], v[40:43], v[76:79]
    buffer_load_dwordx4 v6, s[32:35], s4 offen offset:1024 lds
    v_mfma_f32_16x16x32_bf16 v[96:99], v[40:43], a[92:95], v[96:99]
    ds_read_b128 v[20:23], v8 offset:24576
    v_accvgpr_read_b32 v222, a206
    s_add_u32 m0, s5, 90112
    v_mfma_f32_16x16x32_bf16 v[56:59], a[84:87], v[40:43], v[56:59]
    ds_read_b64_tr_b16 a[114:115], v12 offset:37376
    s_waitcnt lgkmcnt(5)
    v_mfma_f32_16x16x32_bf16 v[80:83], a[88:91], v[44:47], v[80:83]
    ds_read_b64_tr_b16 a[116:117], v12 offset:45056
    v_mfma_f32_16x16x32_bf16 v[100:103], v[44:47], a[92:95], v[100:103]
    buffer_load_dwordx4 v7, s[32:35], s4 offen offset:1024 lds
    v_mfma_f32_16x16x32_bf16 v[60:63], a[84:87], v[44:47], v[60:63]
    ds_read_b128 v[24:27], v8 offset:40960
    s_add_u32 m0, s5, 96256
    v_mfma_f32_16x16x32_bf16 v[84:87], a[88:91], v[48:51], v[84:87]
    ds_read_b64_tr_b16 a[118:119], v12 offset:45568
    v_mfma_f32_16x16x32_bf16 v[104:107], v[48:51], a[92:95], v[104:107]
    ds_read_b64_tr_b16 a[108:109], v12 offset:28672
    v_accvgpr_read_b32 v223, a207
    v_mfma_f32_16x16x32_bf16 v[64:67], a[84:87], v[48:51], v[64:67]
    ds_read_b64_tr_b16 a[110:111], v12 offset:29184
    v_mfma_f32_16x16x32_bf16 v[88:91], a[88:91], v[52:55], v[88:91]
    buffer_load_dwordx4 v6, s[32:35], s4 offen offset:2048 lds
    v_mfma_f32_16x16x32_bf16 v[108:111], v[52:55], a[92:95], v[108:111]
    ds_read_b128 v[28:31], v8 offset:57344
    s_add_u32 m0, s5, 97280
    v_mfma_f32_16x16x32_bf16 v[68:71], a[84:87], v[52:55], v[68:71]
    ds_read_b128 v[32:35], v10 offset:8192
    s_waitcnt lgkmcnt(5)
    v_mfma_f32_16x16x32_bf16 v[72:75], a[100:103], v[16:19], v[72:75]
    ds_read_b128 v[36:39], v9 offset:9216
    v_mfma_f32_16x16x32_bf16 v[92:95], v[16:19], a[104:107], v[92:95]
    buffer_load_dwordx4 v7, s[32:35], s4 offen offset:2048 lds
    v_mfma_f32_16x16x32_bf16 v[76:79], a[100:103], v[20:23], v[76:79]
    ds_read_b128 v[40:43], v9 offset:25600
    v_mov_b32 v224, 0x3f803f80
    v_mfma_f32_16x16x32_bf16 v[96:99], v[20:23], a[104:107], v[96:99]
    s_waitcnt vmcnt(6) lgkmcnt(4)
    s_barrier
    ds_read_b128 v[44:47], v9 offset:41984
    v_mfma_f32_16x16x32_bf16 v[56:59], a[96:99], v[20:23], v[56:59]
    ds_read_b64_tr_b16 a[124:125], v13 offset:8192
    s_add_u32 s4, s17, 1376256
    v_mfma_f32_16x16x32_bf16 v[80:83], a[100:103], v[24:27], v[80:83]
    ds_read_b64_tr_b16 a[126:127], v13 offset:8704
    s_add_u32 m0, s5, 106496
    v_mfma_f32_16x16x32_bf16 v[100:103], v[24:27], a[104:107], v[100:103]
    buffer_load_dwordx4 v6, s[32:35], s4 offen lds
    v_mfma_f32_16x16x32_bf16 v[60:63], a[96:99], v[24:27], v[60:63]
    ds_read_b128 v[48:51], v9 offset:58368
    s_add_u32 m0, s5, 107520
    s_waitcnt lgkmcnt(4)
    v_mfma_f32_16x16x32_bf16 v[84:87], a[100:103], v[28:31], v[84:87]
    ds_read_b64_tr_b16 a[128:129], v13 offset:16384
    v_mov_b32 v225, 0x3f803f80
    v_mfma_f32_16x16x32_bf16 v[104:107], v[28:31], a[104:107], v[104:107]
    ds_read_b64_tr_b16 a[130:131], v13 offset:16896
    v_mfma_f32_16x16x32_bf16 v[64:67], a[96:99], v[28:31], v[64:67]
    ds_read_b128 v[52:55], v11 offset:9216
    v_mfma_f32_16x16x32_bf16 v[88:91], a[100:103], v[32:35], v[88:91]
    buffer_load_dwordx4 v7, s[32:35], s4 offen lds
    v_mfma_f32_16x16x32_bf16 v[108:111], v[32:35], a[104:107], v[108:111]
    ds_read_b64_tr_b16 a[120:121], v13 offset:0
    s_add_u32 m0, s5, 113664
    v_mfma_f32_16x16x32_bf16 v[68:71], a[96:99], v[32:35], v[68:71]
    ds_read_b64_tr_b16 a[122:123], v13 offset:512
    v_mfma_f32_16x16x32_bf16 v[72:75], a[112:115], v[36:39], v[72:75]
    ds_read_b128 v[16:19], v8 offset:10240
    v_mfma_f32_16x16x32_bf16 v[92:95], v[36:39], a[116:119], v[92:95]
    ds_read_b64_tr_b16 a[136:137], v13 offset:12288
    v_mov_b32 v226, 0x3f803f80
    v_mfma_f32_16x16x32_bf16 v[76:79], a[112:115], v[40:43], v[76:79]
    buffer_load_dwordx4 v6, s[32:35], s4 offen offset:1024 lds
    v_mfma_f32_16x16x32_bf16 v[96:99], v[40:43], a[116:119], v[96:99]
    ds_read_b128 v[20:23], v8 offset:26624
    s_add_u32 m0, s5, 114688
    v_mfma_f32_16x16x32_bf16 v[56:59], a[108:111], v[40:43], v[56:59]
    ds_read_b64_tr_b16 a[138:139], v13 offset:12800
    s_waitcnt lgkmcnt(5)
    v_mfma_f32_16x16x32_bf16 v[80:83], a[112:115], v[44:47], v[80:83]
    ds_read_b64_tr_b16 a[140:141], v13 offset:20480
    v_mfma_f32_16x16x32_bf16 v[100:103], v[44:47], a[116:119], v[100:103]
    buffer_load_dwordx4 v7, s[32:35], s4 offen offset:1024 lds
    v_mfma_f32_16x16x32_bf16 v[60:63], a[108:111], v[44:47], v[60:63]
    ds_read_b128 v[24:27], v8 offset:43008
    v_mov_b32 v227, 0x3f803f80
    s_add_u32 m0, s5, 120832
    v_mfma_f32_16x16x32_bf16 v[84:87], a[112:115], v[48:51], v[84:87]
    ds_read_b64_tr_b16 a[142:143], v13 offset:20992
    v_mfma_f32_16x16x32_bf16 v[104:107], v[48:51], a[116:119], v[104:107]
    ds_read_b64_tr_b16 a[132:133], v13 offset:4096
    v_mfma_f32_16x16x32_bf16 v[64:67], a[108:111], v[48:51], v[64:67]
    ds_read_b64_tr_b16 a[134:135], v13 offset:4608
    v_mfma_f32_16x16x32_bf16 v[88:91], a[112:115], v[52:55], v[88:91]
    buffer_load_dwordx4 v6, s[32:35], s4 offen offset:2048 lds
    v_mfma_f32_16x16x32_bf16 v[108:111], v[52:55], a[116:119], v[108:111]
    ds_read_b128 v[28:31], v8 offset:59392
    s_add_u32 m0, s5, 121856
    v_mfma_f32_16x16x32_bf16 v[68:71], a[108:111], v[52:55], v[68:71]
    ds_read_b128 v[32:35], v10 offset:10240
    s_waitcnt lgkmcnt(5)
    v_mfma_f32_16x16x32_bf16 v[72:75], a[124:127], v[16:19], v[72:75]
    ds_read_b128 v[36:39], v9 offset:11264
    v_mfma_f32_16x16x32_bf16 v[92:95], v[16:19], a[128:131], v[92:95]
    buffer_load_dwordx4 v7, s[32:35], s4 offen offset:2048 lds
    v_mfma_f32_16x16x32_bf16 v[76:79], a[124:127], v[20:23], v[76:79]
    ds_read_b128 v[40:43], v9 offset:27648
    v_mfma_f32_16x16x32_bf16 v[96:99], v[20:23], a[128:131], v[96:99]
    s_waitcnt vmcnt(6) lgkmcnt(4)
    s_barrier
    ds_read_b128 v[44:47], v9 offset:44032
    v_mfma_f32_16x16x32_bf16 v[56:59], a[120:123], v[20:23], v[56:59]
    ds_read_b64_tr_b16 a[148:149], v12 offset:8192
    s_mul_i32 s4, s78, 262144
    v_mfma_f32_16x16x32_bf16 v[80:83], a[124:127], v[24:27], v[80:83]
    ds_read_b64_tr_b16 a[150:151], v12 offset:8704
    s_lshl_b32 s5, s77, 13
    v_mfma_f32_16x16x32_bf16 v[100:103], v[24:27], a[128:131], v[100:103]
    s_add_u32 s4, s4, s5
    s_add_u32 s4, s4, s11
    s_mul_i32 s5, s78, 12288
    v_mfma_f32_16x16x32_bf16 v[60:63], a[120:123], v[24:27], v[60:63]
    ds_read_b128 v[48:51], v9 offset:60416
    s_lshl_b32 s6, s77, 10
    s_waitcnt lgkmcnt(4)
    v_mfma_f32_16x16x32_bf16 v[84:87], a[124:127], v[28:31], v[84:87]
    ds_read_b64_tr_b16 a[152:153], v12 offset:16384
    s_add_u32 s5, s5, s6
    v_mfma_f32_16x16x32_bf16 v[104:107], v[28:31], a[128:131], v[104:107]
    ds_read_b64_tr_b16 a[154:155], v12 offset:16896
    s_add_u32 m0, s5, 131072
    v_mfma_f32_16x16x32_bf16 v[64:67], a[120:123], v[28:31], v[64:67]
    ds_read_b128 v[52:55], v11 offset:11264
    s_add_u32 s6, s4, 0
    v_mfma_f32_16x16x32_bf16 v[88:91], a[124:127], v[32:35], v[88:91]
    buffer_load_dwordx4 v4, s[36:39], s6 offen lds
    v_mfma_f32_16x16x32_bf16 v[108:111], v[32:35], a[128:131], v[108:111]
    ds_read_b64_tr_b16 a[144:145], v12 offset:0
    s_add_u32 m0, s5, 133120
    v_mfma_f32_16x16x32_bf16 v[68:71], a[120:123], v[32:35], v[68:71]
    ds_read_b64_tr_b16 a[146:147], v12 offset:512
    s_add_u32 s6, s4, 16384
    v_mfma_f32_16x16x32_bf16 v[72:75], a[136:139], v[36:39], v[72:75]
    ds_read_b128 v[16:19], v8 offset:12288
    v_mfma_f32_16x16x32_bf16 v[92:95], v[36:39], a[140:143], v[92:95]
    ds_read_b64_tr_b16 a[160:161], v12 offset:12288
    v_mfma_f32_16x16x32_bf16 v[76:79], a[136:139], v[40:43], v[76:79]
    buffer_load_dwordx4 v4, s[36:39], s6 offen lds
    v_mfma_f32_16x16x32_bf16 v[96:99], v[40:43], a[140:143], v[96:99]
    ds_read_b128 v[20:23], v8 offset:28672
    s_add_u32 m0, s5, 135168
    v_mfma_f32_16x16x32_bf16 v[56:59], a[132:135], v[40:43], v[56:59]
    ds_read_b64_tr_b16 a[162:163], v12 offset:12800
    s_add_u32 s6, s4, 32768
    s_waitcnt lgkmcnt(5)
    v_mfma_f32_16x16x32_bf16 v[80:83], a[136:139], v[44:47], v[80:83]
    ds_read_b64_tr_b16 a[164:165], v12 offset:20480
    v_mfma_f32_16x16x32_bf16 v[100:103], v[44:47], a[140:143], v[100:103]
    buffer_load_dwordx4 v4, s[36:39], s6 offen lds
    v_mfma_f32_16x16x32_bf16 v[60:63], a[132:135], v[44:47], v[60:63]
    ds_read_b128 v[24:27], v8 offset:45056
    s_add_u32 m0, s5, 137216
    v_mfma_f32_16x16x32_bf16 v[84:87], a[136:139], v[48:51], v[84:87]
    ds_read_b64_tr_b16 a[166:167], v12 offset:20992
    s_add_u32 s6, s4, 49152
    v_mfma_f32_16x16x32_bf16 v[104:107], v[48:51], a[140:143], v[104:107]
    ds_read_b64_tr_b16 a[156:157], v12 offset:4096
    v_mfma_f32_16x16x32_bf16 v[64:67], a[132:135], v[48:51], v[64:67]
    ds_read_b64_tr_b16 a[158:159], v12 offset:4608
    v_mfma_f32_16x16x32_bf16 v[88:91], a[136:139], v[52:55], v[88:91]
    buffer_load_dwordx4 v4, s[36:39], s6 offen lds
    v_mfma_f32_16x16x32_bf16 v[108:111], v[52:55], a[140:143], v[108:111]
    ds_read_b128 v[28:31], v8 offset:61440
    s_add_u32 m0, s5, 139264
    v_mfma_f32_16x16x32_bf16 v[68:71], a[132:135], v[52:55], v[68:71]
    ds_read_b128 v[32:35], v10 offset:12288
    s_add_u32 s6, s4, 65536
    s_waitcnt lgkmcnt(5)
    v_mfma_f32_16x16x32_bf16 v[72:75], a[148:151], v[16:19], v[72:75]
    ds_read_b128 v[36:39], v9 offset:13312
    v_mfma_f32_16x16x32_bf16 v[92:95], v[16:19], a[152:155], v[92:95]
    buffer_load_dwordx4 v4, s[36:39], s6 offen lds
    v_mfma_f32_16x16x32_bf16 v[76:79], a[148:151], v[20:23], v[76:79]
    ds_read_b128 v[40:43], v9 offset:29696
    s_add_u32 m0, s5, 141312
    v_mfma_f32_16x16x32_bf16 v[96:99], v[20:23], a[152:155], v[96:99]
    s_waitcnt vmcnt(5) lgkmcnt(4)
    s_barrier
    ds_read_b128 v[44:47], v9 offset:46080
    v_mfma_f32_16x16x32_bf16 v[56:59], a[144:147], v[20:23], v[56:59]
    ds_read_b64_tr_b16 a[172:173], v12 offset:32768
    s_add_u32 s6, s4, 81920
    v_mfma_f32_16x16x32_bf16 v[80:83], a[148:151], v[24:27], v[80:83]
    ds_read_b64_tr_b16 a[174:175], v12 offset:33280
    v_mfma_f32_16x16x32_bf16 v[100:103], v[24:27], a[152:155], v[100:103]
    buffer_load_dwordx4 v4, s[36:39], s6 offen lds
    v_mfma_f32_16x16x32_bf16 v[60:63], a[144:147], v[24:27], v[60:63]
    ds_read_b128 v[48:51], v9 offset:62464
    s_mul_i32 s4, s78, 262144
    s_waitcnt lgkmcnt(5)
    v_mfma_f32_16x16x32_bf16 v[84:87], a[148:151], v[28:31], v[84:87]
    ds_read_b64_tr_b16 a[176:177], v12 offset:40960
    s_lshl_b32 s5, s77, 13
    v_mfma_f32_16x16x32_bf16 v[104:107], v[28:31], a[152:155], v[104:107]
    ds_read_b64_tr_b16 a[178:179], v12 offset:41472
    s_add_u32 s4, s4, s5
    v_mfma_f32_16x16x32_bf16 v[64:67], a[144:147], v[28:31], v[64:67]
    ds_read_b128 v[52:55], v11 offset:13312
    s_add_u32 s4, s4, s11
    v_mfma_f32_16x16x32_bf16 v[88:91], a[148:151], v[32:35], v[88:91]
    s_mul_i32 s5, s78, 12288
    s_lshl_b32 s6, s77, 10
    s_add_u32 s5, s5, s6
    v_mfma_f32_16x16x32_bf16 v[108:111], v[32:35], a[152:155], v[108:111]
    ds_read_b64_tr_b16 a[168:169], v12 offset:24576
    s_add_u32 m0, s5, 81920
    v_mfma_f32_16x16x32_bf16 v[68:71], a[144:147], v[32:35], v[68:71]
    ds_read_b64_tr_b16 a[170:171], v12 offset:25088
    s_add_u32 s6, s4, 98304
    v_mfma_f32_16x16x32_bf16 v[72:75], a[160:163], v[36:39], v[72:75]
    ds_read_b128 v[16:19], v8 offset:14336
    v_mfma_f32_16x16x32_bf16 v[92:95], v[36:39], a[164:167], v[92:95]
    ds_read_b64_tr_b16 a[184:185], v12 offset:36864
    s_waitcnt lgkmcnt(4)
    v_mfma_f32_16x16x32_bf16 v[76:79], a[160:163], v[40:43], v[76:79]
    buffer_load_dwordx4 v4, s[36:39], s6 offen lds
    v_mfma_f32_16x16x32_bf16 v[96:99], v[40:43], a[164:167], v[96:99]
    ds_read_b128 v[20:23], v8 offset:30720
    s_add_u32 m0, s5, 83968
    v_mfma_f32_16x16x32_bf16 v[56:59], a[156:159], v[40:43], v[56:59]
    ds_read_b64_tr_b16 a[186:187], v12 offset:37376
    s_add_u32 s6, s4, 114688
    v_mfma_f32_16x16x32_bf16 v[80:83], a[160:163], v[44:47], v[80:83]
    ds_read_b64_tr_b16 a[188:189], v12 offset:45056
    v_mfma_f32_16x16x32_bf16 v[100:103], v[44:47], a[164:167], v[100:103]
    buffer_load_dwordx4 v4, s[36:39], s6 offen lds
    v_mfma_f32_16x16x32_bf16 v[60:63], a[156:159], v[44:47], v[60:63]
    ds_read_b128 v[24:27], v8 offset:47104
    s_add_u32 m0, s5, 86016
    v_mfma_f32_16x16x32_bf16 v[84:87], a[160:163], v[48:51], v[84:87]
    ds_read_b64_tr_b16 a[190:191], v12 offset:45568
    s_add_u32 s6, s4, 131072
    v_mfma_f32_16x16x32_bf16 v[104:107], v[48:51], a[164:167], v[104:107]
    ds_read_b64_tr_b16 a[180:181], v12 offset:28672
    v_mfma_f32_16x16x32_bf16 v[64:67], a[156:159], v[48:51], v[64:67]
    ds_read_b64_tr_b16 a[182:183], v12 offset:29184
    v_mfma_f32_16x16x32_bf16 v[88:91], a[160:163], v[52:55], v[88:91]
    buffer_load_dwordx4 v4, s[36:39], s6 offen lds
    v_mfma_f32_16x16x32_bf16 v[108:111], v[52:55], a[164:167], v[108:111]
    ds_read_b128 v[28:31], v8 offset:63488
    s_add_u32 m0, s5, 88064
    v_mfma_f32_16x16x32_bf16 v[68:71], a[156:159], v[52:55], v[68:71]
    ds_read_b128 v[32:35], v10 offset:14336
    s_add_u32 s6, s4, 147456
    s_waitcnt lgkmcnt(5)
    v_mfma_f32_16x16x32_bf16 v[72:75], a[172:175], v[16:19], v[72:75]
    ds_read_b128 v[36:39], v9 offset:15360
    v_mfma_f32_16x16x32_bf16 v[92:95], v[16:19], a[176:179], v[92:95]
    buffer_load_dwordx4 v4, s[36:39], s6 offen lds
    v_mfma_f32_16x16x32_bf16 v[76:79], a[172:175], v[20:23], v[76:79]
    ds_read_b128 v[40:43], v9 offset:31744
    s_add_u32 m0, s5, 90112
    v_mfma_f32_16x16x32_bf16 v[96:99], v[20:23], a[176:179], v[96:99]
    s_waitcnt lgkmcnt(4)
    s_barrier
    ds_read_b128 v[44:47], v9 offset:48128
    v_mfma_f32_16x16x32_bf16 v[56:59], a[168:171], v[20:23], v[56:59]
    s_add_u32 s6, s4, 163840
    v_mfma_f32_16x16x32_bf16 v[80:83], a[172:175], v[24:27], v[80:83]
    buffer_load_dwordx4 v4, s[36:39], s6 offen lds
    v_mfma_f32_16x16x32_bf16 v[100:103], v[24:27], a[176:179], v[100:103]
    s_mul_i32 s4, s78, 262144
    s_lshl_b32 s5, s77, 13
    s_add_u32 s4, s4, s5
    v_mfma_f32_16x16x32_bf16 v[60:63], a[168:171], v[24:27], v[60:63]
    ds_read_b128 v[48:51], v9 offset:64512
    s_add_u32 s4, s4, s11
    s_waitcnt lgkmcnt(2)
    v_mfma_f32_16x16x32_bf16 v[84:87], a[172:175], v[28:31], v[84:87]
    s_mul_i32 s5, s78, 12288
    s_lshl_b32 s6, s77, 10
    s_add_u32 s5, s5, s6
    v_mfma_f32_16x16x32_bf16 v[104:107], v[28:31], a[176:179], v[104:107]
    s_add_u32 m0, s5, 106496
    s_add_u32 s6, s4, 180224
    v_mfma_f32_16x16x32_bf16 v[64:67], a[168:171], v[28:31], v[64:67]
    ds_read_b128 v[52:55], v11 offset:15360
    v_mfma_f32_16x16x32_bf16 v[88:91], a[172:175], v[32:35], v[88:91]
    buffer_load_dwordx4 v4, s[36:39], s6 offen lds
    v_mfma_f32_16x16x32_bf16 v[108:111], v[32:35], a[176:179], v[108:111]
    s_add_u32 m0, s5, 108544
    s_add_u32 s6, s4, 196608
    v_mfma_f32_16x16x32_bf16 v[68:71], a[168:171], v[32:35], v[68:71]
    buffer_load_dwordx4 v4, s[36:39], s6 offen lds
    v_mfma_f32_16x16x32_bf16 v[72:75], a[184:187], v[36:39], v[72:75]
    s_add_u32 m0, s5, 110592
    s_add_u32 s6, s4, 212992
    v_mfma_f32_16x16x32_bf16 v[92:95], v[36:39], a[188:191], v[92:95]
    buffer_load_dwordx4 v4, s[36:39], s6 offen lds
    v_mfma_f32_16x16x32_bf16 v[76:79], a[184:187], v[40:43], v[76:79]
    s_add_u32 m0, s5, 112640
    s_add_u32 s6, s4, 229376
    v_mfma_f32_16x16x32_bf16 v[96:99], v[40:43], a[188:191], v[96:99]
    buffer_load_dwordx4 v4, s[36:39], s6 offen lds
    v_mfma_f32_16x16x32_bf16 v[56:59], a[180:183], v[40:43], v[56:59]
    s_add_u32 m0, s5, 114688
    s_add_u32 s6, s4, 245760
    s_waitcnt lgkmcnt(0)
    v_mfma_f32_16x16x32_bf16 v[80:83], a[184:187], v[44:47], v[80:83]
    buffer_load_dwordx4 v4, s[36:39], s6 offen lds
    v_accvgpr_read_b32 v5, a209
    v_mfma_f32_16x16x32_bf16 v[100:103], v[44:47], a[188:191], v[100:103]
    buffer_load_dwordx2 a[232:233], v5, s[64:67], s74 offen offset:2048 sc1
    v_mfma_f32_16x16x32_bf16 v[60:63], a[180:183], v[44:47], v[60:63]
    v_mfma_f32_16x16x32_bf16 v[84:87], a[184:187], v[48:51], v[84:87]
    v_mfma_f32_16x16x32_bf16 v[104:107], v[48:51], a[188:191], v[104:107]
    v_mfma_f32_16x16x32_bf16 v[64:67], a[180:183], v[48:51], v[64:67]
    v_mfma_f32_16x16x32_bf16 v[88:91], a[184:187], v[52:55], v[88:91]
    v_mfma_f32_16x16x32_bf16 v[108:111], v[52:55], a[188:191], v[108:111]
    v_mfma_f32_16x16x32_bf16 v[68:71], a[180:183], v[52:55], v[68:71]
    v_accvgpr_read_b32 v6, a212
    v_xor_b32 v13, 32, v6
    s_barrier
    v_cvt_pk_bf16_f32 v24, v72, v73
    s_lshl_b32 s4, s22, 2
    v_cvt_pk_bf16_f32 v25, v74, v75
    v_cvt_pk_bf16_f32 v26, v76, v77
    v_cvt_pk_bf16_f32 v27, v78, v79
    s_add_u32 s4, s4, s68
    v_cvt_pk_bf16_f32 v28, v80, v81
    v_cvt_pk_bf16_f32 v29, v82, v83
    v_cvt_pk_bf16_f32 v30, v84, v85
    s_mul_i32 s4, s4, 88064
    v_cvt_pk_bf16_f32 v31, v86, v87
    v_cvt_pk_bf16_f32 v32, v88, v89
    v_cvt_pk_bf16_f32 v33, v90, v91
    v_cvt_pk_bf16_f32 v16, v56, v57
    s_add_u32 s4, s4, s12
    v_cvt_pk_bf16_f32 v17, v58, v59
    v_cvt_pk_bf16_f32 v18, v60, v61
    v_cvt_pk_bf16_f32 v19, v62, v63
    s_lshl_b32 s5, s68, 11
    v_cvt_pk_bf16_f32 v20, v64, v65
    v_cvt_pk_bf16_f32 v21, v66, v67
    v_cvt_pk_bf16_f32 v22, v68, v69
    s_add_u32 m0, s5, 49152
    v_cvt_pk_bf16_f32 v23, v70, v71
    v_mfma_f32_16x16x16_bf16 v[136:139], v[24:25], v[16:17], v[216:219]
    v_cvt_pk_bf16_f32 v34, v92, v93
    v_cvt_pk_bf16_f32 v35, v94, v95
    buffer_load_dwordx4 v6, s[40:43], s4 offen lds
    v_mfma_f32_16x16x16_bf16 v[140:143], v[26:27], v[16:17], v[208:211]
    v_cvt_pk_bf16_f32 v40, v92, v93
    v_mfma_f32_16x16x16_bf16 v[144:147], v[24:25], v[18:19], v[220:223]
    s_add_u32 m0, s5, 57280
    v_cvt_pk_bf16_f32 v41, v94, v95
    v_cvt_pk_bf16_f32 v36, v96, v97
    v_mfma_f32_16x16x16_bf16 v[148:151], v[28:29], v[18:19], v[208:211]
    v_cvt_pk_bf16_f32 v37, v98, v99
    buffer_load_dwordx4 v6, s[40:43], s4 offen offset:64 lds
    v_mfma_f32_16x16x16_bf16 v[152:155], v[26:27], v[20:21], v[212:215]
    v_cvt_pk_bf16_f32 v42, v100, v101
    v_cvt_pk_bf16_f32 v43, v102, v103
    s_add_u32 m0, s5, 65408
    v_mfma_f32_16x16x16_bf16 v[156:159], v[30:31], v[20:21], v[208:211]
    v_cvt_pk_bf16_f32 v38, v104, v105
    v_mfma_f32_16x16x16_bf16 v[160:163], v[28:29], v[22:23], v[212:215]
    buffer_load_dwordx4 v6, s[40:43], s4 offen offset:128 lds
    v_cvt_pk_bf16_f32 v39, v106, v107
    v_cvt_pk_bf16_f32 v44, v108, v109
    v_mfma_f32_16x16x16_bf16 v[164:167], v[32:33], v[22:23], v[208:211]
    v_cvt_pk_bf16_f32 v45, v110, v111
    s_add_u32 s4, s4, 44032
    s_mov_b32 s100, 0x3eb8aa3b
    v_max3_f32 v168, v136, v137, v138
    v_max3_f32 v169, v139, v140, v141
    s_add_u32 m0, s5, 50176
    v_max3_f32 v168, v168, v142, v143
    v_max_f32_e64 v168, v168, v169
    v_max3_f32 v170, v144, v145, v146
    buffer_load_dwordx4 v6, s[40:43], s4 offen lds
    v_max3_f32 v171, v147, v148, v149
    v_max3_f32 v170, v170, v150, v151
    v_max_f32_e64 v170, v170, v171
    v_max3_f32 v172, v152, v153, v154
    s_add_u32 m0, s5, 58304
    v_max3_f32 v173, v155, v156, v157
    v_max3_f32 v172, v172, v158, v159
    v_max_f32_e64 v172, v172, v173
    buffer_load_dwordx4 v6, s[40:43], s4 offen offset:64 lds
    v_max3_f32 v174, v160, v161, v162
    v_max3_f32 v175, v163, v164, v165
    v_max3_f32 v174, v174, v166, v167
    v_max_f32_e64 v174, v174, v175
    s_add_u32 m0, s5, 66432
    v_mov_b32 v169, v168
    v_mov_b32 v171, v170
    v_mov_b32_e64 v173, v172
    buffer_load_dwordx4 v6, s[40:43], s4 offen offset:128 lds
    v_mov_b32 v175, v174
    v_permlane16_swap_b32 v168, v169
    v_permlane16_swap_b32 v170, v171
    v_accvgpr_read_b32 v5, a208
    v_permlane16_swap_b32 v172, v173
    v_permlane16_swap_b32 v174, v175
    v_max_f32 v168, v168, v169
    v_max_f32_e64 v170, v170, v171
    s_mov_b32 s13, 65536
    v_max_f32 v172, v172, v173
    v_max_f32 v174, v174, v175
    v_mov_b32_e64 v169, v168
    buffer_load_dwordx4 v[112:115], v5, s[64:67], s13 offen sc1
    v_mov_b32 v171, v170
    v_mov_b32 v173, v172
    v_mov_b32_e64 v175, v174
    s_mov_b32 s13, 77824
    v_permlane32_swap_b32 v168, v169
    v_permlane32_swap_b32 v170, v171
    v_permlane32_swap_b32 v172, v173
    v_permlane32_swap_b32 v174, v175
    buffer_load_dwordx4 v[116:119], v5, s[64:67], s13 offen sc1
    v_max_f32 v168, v168, v169
    v_max_f32 v170, v170, v171
    v_max_f32_e64 v172, v172, v173
    s_mov_b32 s13, 90112
    v_max_f32_e64 v174, v174, v175
    v_mul_f32_e64 v168, -s100, v168
    v_mul_f32_e64 v170, -s100, v170
    v_mul_f32_e64 v172, -s100, v172
    buffer_load_dwordx4 v[120:123], v5, s[64:67], s13 offen sc1
    v_mul_f32_e64 v174, -s100, v174
    s_mov_b32 s101, s100
    s_nop 0
    v_pk_fma_f32 v[136:137], v[136:137], s[100:101], v[168:169] op_sel_hi:[1,1,0]
    s_mov_b32 s13, 102400
    v_pk_fma_f32 v[138:139], v[138:139], s[100:101], v[168:169] op_sel_hi:[1,1,0]
    v_pk_fma_f32 v[140:141], v[140:141], s[100:101], v[168:169] op_sel_hi:[1,1,0]
    v_pk_fma_f32 v[142:143], v[142:143], s[100:101], v[168:169] op_sel_hi:[1,1,0]
    buffer_load_dwordx4 v[124:127], v5, s[64:67], s13 offen sc1
    v_pk_fma_f32 v[144:145], v[144:145], s[100:101], v[170:171] op_sel_hi:[1,1,0]
    v_pk_fma_f32 v[146:147], v[146:147], s[100:101], v[170:171] op_sel_hi:[1,1,0]
    v_pk_fma_f32 v[148:149], v[148:149], s[100:101], v[170:171] op_sel_hi:[1,1,0]
    v_pk_fma_f32 v[150:151], v[150:151], s[100:101], v[170:171] op_sel_hi:[1,1,0]
    s_lshl_b32 s4, s21, 2
    v_pk_fma_f32 v[152:153], v[152:153], s[100:101], v[172:173] op_sel_hi:[1,1,0]
    v_pk_fma_f32 v[154:155], v[154:155], s[100:101], v[172:173] op_sel_hi:[1,1,0]
    v_pk_fma_f32 v[156:157], v[156:157], s[100:101], v[172:173] op_sel_hi:[1,1,0]
    s_add_u32 s4, s4, s68
    v_pk_fma_f32 v[158:159], v[158:159], s[100:101], v[172:173] op_sel_hi:[1,1,0]
    v_pk_fma_f32 v[160:161], v[160:161], s[100:101], v[174:175] op_sel_hi:[1,1,0]
    v_pk_fma_f32 v[162:163], v[162:163], s[100:101], v[174:175] op_sel_hi:[1,1,0]
    s_mul_i32 s4, s4, 88064
    v_pk_fma_f32 v[164:165], v[164:165], s[100:101], v[174:175] op_sel_hi:[1,1,0]
    v_pk_fma_f32 v[166:167], v[166:167], s[100:101], v[174:175] op_sel_hi:[1,1,0]
    v_exp_f32 v136, v136
    v_exp_f32 v137, v137
    s_add_u32 s4, s4, s12
    v_exp_f32 v138, v138
    v_exp_f32 v139, v139
    v_exp_f32 v140, v140
    s_lshl_b32 s5, s68, 11
    v_exp_f32 v141, v141
    v_exp_f32 v142, v142
    v_exp_f32 v143, v143
    v_cvt_pk_bf16_f32 v136, v136, v137
    s_add_u32 m0, s5, 0
    v_cvt_pk_bf16_f32 v137, v138, v139
    v_cvt_pk_bf16_f32 v138, v140, v141
    v_cvt_pk_bf16_f32 v139, v142, v143
    buffer_load_dwordx4 v6, s[40:43], s4 offen lds
    v_exp_f32 v144, v144
    v_exp_f32_e64 v145, v145
    v_mfma_f32_16x16x32_bf16 v[176:179], v[34:37], v[136:139], 0
    s_add_u32 m0, s5, 16320
    v_mfma_f32_16x16x32_bf16 v[140:143], v[224:227], v[136:139], 0
    v_exp_f32 v146, v146
    v_exp_f32 v147, v147
    v_exp_f32_e64 v148, v148
    buffer_load_dwordx4 v6, s[40:43], s4 offen offset:64 lds
    v_exp_f32 v149, v149
    v_exp_f32 v150, v150
    v_exp_f32_e64 v151, v151
    s_add_u32 m0, s5, 32640
    v_cvt_pk_bf16_f32 v144, v144, v145
    v_cvt_pk_bf16_f32 v145, v146, v147
    v_cvt_pk_bf16_f32 v146, v148, v149
    buffer_load_dwordx4 v6, s[40:43], s4 offen offset:128 lds
    v_cvt_pk_bf16_f32 v147, v150, v151
    v_exp_f32 v152, v152
    v_exp_f32 v153, v153
    v_mfma_f32_16x16x32_bf16 v[180:183], v[40:43], v[144:147], 0
    s_add_u32 m0, s5, 8192
    v_mfma_f32_16x16x32_bf16 v[148:151], v[224:227], v[144:147], 0
    v_exp_f32 v154, v154
    v_exp_f32 v155, v155
    buffer_load_dwordx4 v13, s[44:47], s4 offen lds
    v_exp_f32 v156, v156
    v_exp_f32 v157, v157
    v_exp_f32 v158, v158
    v_exp_f32 v159, v159
    s_add_u32 m0, s5, 24512
    v_cvt_pk_bf16_f32 v152, v152, v153
    v_cvt_pk_bf16_f32 v153, v154, v155
    v_cvt_pk_bf16_f32 v154, v156, v157
    buffer_load_dwordx4 v13, s[44:47], s4 offen offset:64 lds
    v_cvt_pk_bf16_f32 v155, v158, v159
    v_rcp_f32 v140, v140
    s_nop 0
    v_mul_f32_e64 v176, v176, v140
    s_add_u32 m0, s5, 40832
    v_mul_f32 v177, v177, v140
    v_mul_f32 v178, v178, v140
    v_mul_f32_e64 v179, v179, v140
    v_cvt_pk_bf16_f32 v16, v176, v177
    buffer_load_dwordx4 v13, s[44:47], s4 offen offset:128 lds
    v_cvt_pk_bf16_f32 v17, v178, v179
    v_exp_f32 v160, v160
    v_exp_f32 v161, v161
    s_add_u32 s4, s4, 44032
    v_mfma_f32_16x16x32_bf16 v[184:187], v[36:39], v[152:155], 0
    v_mfma_f32_16x16x32_bf16 v[156:159], v[224:227], v[152:155], 0
    v_exp_f32 v162, v162
    v_exp_f32 v163, v163
    v_exp_f32 v164, v164
    v_exp_f32 v165, v165
    v_exp_f32 v166, v166
    v_exp_f32 v167, v167
    v_cvt_pk_bf16_f32 v160, v160, v161
    v_cvt_pk_bf16_f32 v161, v162, v163
    v_cvt_pk_bf16_f32 v162, v164, v165
    v_cvt_pk_bf16_f32 v163, v166, v167
    v_rcp_f32 v148, v148
    s_nop 0
    v_mul_f32 v180, v180, v148
    v_mul_f32 v181, v181, v148
    v_mul_f32 v182, v182, v148
    v_mul_f32 v183, v183, v148
    v_cvt_pk_bf16_f32 v18, v180, v181
    v_cvt_pk_bf16_f32 v19, v182, v183
    s_waitcnt vmcnt(16)
    v_accvgpr_read_b32 v236, a232
    v_accvgpr_read_b32 v237, a233
    v_mfma_f32_16x16x32_bf16 v[188:191], v[42:45], v[160:163], 0
    v_mfma_f32_16x16x32_bf16 v[164:167], v[224:227], v[160:163], 0
    v_rcp_f32 v156, v156
    s_nop 0
    v_mul_f32 v184, v184, v156
    v_mul_f32 v185, v185, v156
    v_mul_f32 v186, v186, v156
    v_mul_f32_e64 v187, v187, v156
    v_cvt_pk_bf16_f32 v20, v184, v185
    v_cvt_pk_bf16_f32 v21, v186, v187
    v_permlane16_swap_b32 v16, v18
    v_permlane16_swap_b32 v17, v19
    v_cmp_eq_u32_e64 vcc, s75, v237
    v_cmp_eq_u32 s[94:95], s76, v236
    s_add_u32 s89, s9, 32768
    s_and_b64 s[94:95], s[94:95], vcc
    s_cmp_eq_u64 s[94:95], -1
    s_cselect_b32 s76, 1, 0
    s_cmp_eq_u32 s76, 0
    s_cbranch_scc1 L_slow_9
    buffer_store_dwordx4 v[16:19], v2, s[60:63], s9 offen
L_join_10:
    v_rcp_f32 v164, v164
    s_nop 0
    v_mul_f32 v188, v188, v164
    v_mul_f32 v189, v189, v164
    v_mul_f32 v190, v190, v164
    v_mul_f32_e64 v191, v191, v164
    v_cvt_pk_bf16_f32 v22, v188, v189
    v_cvt_pk_bf16_f32 v23, v190, v191
    s_nop 0
    v_permlane16_swap_b32 v20, v22
    v_permlane16_swap_b32 v21, v23
    s_cmp_eq_u32 s76, 0
    s_cbranch_scc1 L_slow_11
    buffer_store_dwordx4 v[20:23], v2, s[60:63], s89 offen
L_join_12:
    s_lshl_b32 s4, s21, 2
    s_add_u32 s4, s4, s68
    s_mul_i32 s4, s4, 88064
    s_add_u32 s4, s4, s12
    s_lshl_b32 s5, s68, 11
    s_add_u32 s4, s4, 44032
    s_add_u32 m0, s5, 1024
    s_nop 0
    buffer_load_dwordx4 v6, s[40:43], s4 offen lds
    s_add_u32 m0, s5, 17344
    s_nop 0
    buffer_load_dwordx4 v6, s[40:43], s4 offen offset:64 lds
    s_add_u32 m0, s5, 33664
    s_nop 0
    buffer_load_dwordx4 v6, s[40:43], s4 offen offset:128 lds
    s_add_u32 m0, s5, 9216
    s_nop 0
    buffer_load_dwordx4 v13, s[44:47], s4 offen lds
    s_add_u32 m0, s5, 25536
    s_nop 0
    buffer_load_dwordx4 v13, s[44:47], s4 offen offset:64 lds
    s_add_u32 m0, s5, 41856
    s_nop 0
    buffer_load_dwordx4 v13, s[44:47], s4 offen offset:128 lds
    v_accvgpr_read_b32 v10, a219
    v_xor_b32 v11, 64, v10
    s_barrier
    s_nop 0
    ds_read_b64_tr_b16 v[128:129], v10 offset:49152
    ds_read_b64_tr_b16 v[130:131], v10 offset:49664
    ds_read_b64_tr_b16 v[132:133], v11 offset:49152
    ds_read_b64_tr_b16 v[134:135], v11 offset:49664
    ds_read_b64_tr_b16 v[136:137], v10 offset:51200
    ds_read_b64_tr_b16 v[138:139], v10 offset:51712
    ds_read_b64_tr_b16 v[140:141], v11 offset:51200
    ds_read_b64_tr_b16 v[142:143], v11 offset:51712
    ds_read_b64_tr_b16 v[144:145], v10 offset:53248
    ds_read_b64_tr_b16 v[146:147], v10 offset:53760
    ds_read_b64_tr_b16 v[148:149], v11 offset:53248
    ds_read_b64_tr_b16 v[150:151], v11 offset:53760
    ds_read_b64_tr_b16 v[152:153], v10 offset:55296
    ds_read_b64_tr_b16 v[154:155], v10 offset:55808
    ds_read_b64_tr_b16 v[156:157], v11 offset:55296
    ds_read_b64_tr_b16 v[158:159], v11 offset:55808
    ds_read_b64_tr_b16 v[160:161], v10 offset:57344
    ds_read_b64_tr_b16 v[162:163], v10 offset:57856
    ds_read_b64_tr_b16 v[164:165], v11 offset:57344
    ds_read_b64_tr_b16 v[166:167], v11 offset:57856
    ds_read_b64_tr_b16 v[168:169], v10 offset:59392
    ds_read_b64_tr_b16 v[170:171], v10 offset:59904
    ds_read_b64_tr_b16 v[172:173], v11 offset:59392
    ds_read_b64_tr_b16 v[174:175], v11 offset:59904
    ds_read_b64_tr_b16 v[176:177], v10 offset:0
    ds_read_b64_tr_b16 v[178:179], v10 offset:512
    ds_read_b64_tr_b16 v[180:181], v11 offset:0
    ds_read_b64_tr_b16 v[182:183], v11 offset:512
    ds_read_b64_tr_b16 v[184:185], v10 offset:2048
    ds_read_b64_tr_b16 v[186:187], v10 offset:2560
    ds_read_b64_tr_b16 v[188:189], v11 offset:2048
    ds_read_b64_tr_b16 v[190:191], v11 offset:2560
    ds_read_b64_tr_b16 v[192:193], v10 offset:4096
    ds_read_b64_tr_b16 v[194:195], v10 offset:4608
    ds_read_b64_tr_b16 v[196:197], v11 offset:4096
    ds_read_b64_tr_b16 v[198:199], v11 offset:4608
    v_mov_b32 v7, s75
    s_waitcnt vmcnt(6)
    s_mov_b64 exec, 1
    s_cmp_eq_u32 s76, 0
    s_cbranch_scc1 L_slow_13
    buffer_store_dword v7, off, s[64:67], s8 offset:0
L_join_14:
    s_mov_b64 exec, -1
    ds_read_b64_tr_b16 v[200:201], v10 offset:6144
    ds_read_b64_tr_b16 v[202:203], v10 offset:6656
    ds_read_b64_tr_b16 v[204:205], v11 offset:6144
    ds_read_b64_tr_b16 v[206:207], v11 offset:6656
    ds_read_b64_tr_b16 v[208:209], v10 offset:8192
    ds_read_b64_tr_b16 v[210:211], v10 offset:8704
    ds_read_b64_tr_b16 v[212:213], v11 offset:8192
    ds_read_b64_tr_b16 v[214:215], v11 offset:8704
    ds_read_b64_tr_b16 v[216:217], v10 offset:24576
    ds_read_b64_tr_b16 v[218:219], v10 offset:25088
    ds_read_b64_tr_b16 v[220:221], v11 offset:24576
    ds_read_b64_tr_b16 v[222:223], v11 offset:25088
    ds_read_b64_tr_b16 v[224:225], v10 offset:26624
    ds_read_b64_tr_b16 v[226:227], v10 offset:27136
    ds_read_b64_tr_b16 v[228:229], v11 offset:26624
    ds_read_b64_tr_b16 v[230:231], v11 offset:27136
    ds_read_b64_tr_b16 v[232:233], v10 offset:28672
    ds_read_b64_tr_b16 v[234:235], v10 offset:29184
    ds_read_b64_tr_b16 v[236:237], v11 offset:28672
    ds_read_b64_tr_b16 v[238:239], v11 offset:29184
    ds_read_b64_tr_b16 v[240:241], v10 offset:30720
    ds_read_b64_tr_b16 v[242:243], v10 offset:31232
    ds_read_b64_tr_b16 v[244:245], v11 offset:30720
    ds_read_b64_tr_b16 v[246:247], v11 offset:31232
    ds_read_b64_tr_b16 v[248:249], v10 offset:32768
    ds_read_b64_tr_b16 v[250:251], v10 offset:33280
    ds_read_b64_tr_b16 v[252:253], v11 offset:32768
    ds_read_b64_tr_b16 v[254:255], v11 offset:33280
    s_and_b32 s88, s71, 1
    s_lshl_b32 s88, s88, 5
    s_lshl_b32 s89, s78, 4
    s_add_u32 s88, s88, s89
    s_mov_b64 s[94:95], 0xffff
    s_lshl_b64 s[92:93], s[94:95], s88
    s_lshl_b32 s88, s78, 14
    s_add_u32 s98, s88, s10
    s_mov_b32 s96, 0
L_poll_15:
    buffer_load_dword v7, v3, s[64:67], s74 offen offset:0 sc1
    s_add_u32 s96, s96, 1
    s_waitcnt vmcnt(0)
    v_cmp_eq_u32 vcc, s75, v7
    s_nop 0
    s_and_b64 s[94:95], vcc, s[92:93]
    s_cmp_eq_u64 s[94:95], s[92:93]
    s_cbranch_scc1 L_pd_16
    s_cmp_lt_u32 s96, 0x80000
    s_cbranch_scc1 L_poll_15
L_pd_16:
    buffer_load_dwordx4 a[0:3], v2, s[60:63], s98 offen offset:0 sc1
    buffer_load_dwordx4 a[4:7], v2, s[60:63], s98 offen offset:1024 sc1
    buffer_load_dwordx4 a[8:11], v2, s[60:63], s98 offen offset:2048 sc1
    buffer_load_dwordx4 a[12:15], v2, s[60:63], s98 offen offset:3072 sc1
    s_add_u32 s98, s98, 4096
    buffer_load_dwordx4 a[16:19], v2, s[60:63], s98 offen offset:0 sc1
    s_mov_b32 s96, 0
    s_nop 0
    s_mov_b32 s100, 0x0c0c0400
    s_mov_b32 s101, 0x04000c0c
L_mchk_17:
    v_perm_b32 v9, v113, v112, s100
    v_perm_b32 v10, v115, v114, s101
    v_bitop3_b32 v8, v9, v10, s75 bitop3:0x56
    v_perm_b32 v9, v117, v116, s100
    v_perm_b32 v10, v119, v118, s101
    v_bitop3_b32 v9, v9, v10, s75 bitop3:0x56
    v_or_b32_e64 v8, v8, v9
    v_perm_b32 v9, v121, v120, s100
    v_perm_b32 v10, v123, v122, s101
    v_bitop3_b32 v9, v9, v10, s75 bitop3:0x56
    v_or_b32_e64 v8, v8, v9
    v_perm_b32 v9, v125, v124, s100
    v_perm_b32 v10, v127, v126, s101
    v_bitop3_b32 v9, v9, v10, s75 bitop3:0x56
    v_or_b32 v8, v8, v9
    v_cmp_ne_u32 vcc, 0, v8
    s_cbranch_vccnz L_mretry_18
L_mchk_17_ok:
    s_waitcnt lgkmcnt(0)
    s_barrier
    s_waitcnt vmcnt(4)
    v_mfma_f32_32x32x16_bf16 v[32:47], v[132:135], a[0:3], 0
    buffer_load_dwordx4 a[20:23], v2, s[60:63], s98 offen offset:1024 sc1
    s_mov_b32 s100, 0xffffff00
    v_mfma_f32_32x32x16_bf16 v[16:31], v[128:131], a[0:3], 0
    buffer_load_dwordx4 a[24:27], v2, s[60:63], s98 offen offset:2048 sc1
    v_and_b32 v112, s100, v112
    v_and_b32 v113, s100, v113
    v_and_b32 v114, s100, v114
    v_and_b32 v115, s100, v115
    v_and_b32 v116, s100, v116
    v_and_b32 v117, s100, v117
    s_waitcnt vmcnt(5)
    v_mfma_f32_32x32x16_bf16 v[32:47], v[140:143], a[4:7], v[32:47]
    buffer_load_dwordx4 a[28:31], v2, s[60:63], s98 offen offset:3072 sc1
    v_and_b32 v118, s100, v118
    v_and_b32 v119, s100, v119
    v_and_b32 v120, s100, v120
    v_and_b32 v121, s100, v121
    v_and_b32 v122, s100, v122
    v_and_b32_e64 v123, s100, v123
    v_mfma_f32_32x32x16_bf16 v[16:31], v[136:139], a[4:7], v[16:31]
    v_and_b32 v124, s100, v124
    v_and_b32 v125, s100, v125
    v_and_b32 v126, s100, v126
    v_and_b32 v127, s100, v127
    v_add_f32 v112, v112, v116
    v_add_f32 v120, v120, v124
    s_add_u32 s98, s98, 4096
    s_waitcnt vmcnt(5)
    v_mfma_f32_32x32x16_bf16 v[32:47], v[148:151], a[8:11], v[32:47]
    buffer_load_dwordx4 a[32:35], v2, s[60:63], s98 offen offset:0 sc1
    v_add_f32 v113, v113, v117
    v_add_f32 v121, v121, v125
    v_add_f32 v114, v114, v118
    v_add_f32 v122, v122, v126
    v_add_f32 v115, v115, v119
    v_add_f32_e64 v123, v123, v127
    v_mfma_f32_32x32x16_bf16 v[16:31], v[144:147], a[8:11], v[16:31]
    v_add_f32 v112, v112, v120
    v_add_f32 v113, v113, v121
    v_add_f32 v114, v114, v122
    v_add_f32 v115, v115, v123
    v_cvt_pk_bf16_f32 v116, v112, v113
    v_cvt_pk_bf16_f32 v117, v114, v115
    v_lshlrev_b32 v112, 16, v116
    s_waitcnt vmcnt(5)
    v_mfma_f32_32x32x16_bf16 v[32:47], v[156:159], a[12:15], v[32:47]
    buffer_load_dwordx4 a[36:39], v2, s[60:63], s98 offen offset:1024 sc1
    v_and_b32 v113, s3, v116
    v_lshlrev_b32 v114, 16, v117
    v_and_b32_e64 v115, s3, v117
    v_bfe_u32 v8, v1, 3, 2
    v_cmp_eq_u32 vcc, 2, v8
    s_nop 1
    v_cndmask_b32_e64 v8, 0, 1.0, vcc
    v_mfma_f32_32x32x16_bf16 v[16:31], v[152:155], a[12:15], v[16:31]
    buffer_load_dwordx4 a[40:43], v2, s[60:63], s98 offen offset:2048 sc1
    v_add_f32 v112, v8, v112
    v_add_f32 v113, v8, v113
    v_add_f32 v114, v8, v114
    v_add_f32 v115, v8, v115
    v_cvt_pk_bf16_f32 v116, v112, v113
    v_cvt_pk_bf16_f32 v117, v114, v115
    s_waitcnt vmcnt(6)
    v_mfma_f32_32x32x16_bf16 v[32:47], v[164:167], a[16:19], v[32:47]
    buffer_load_dwordx4 a[44:47], v2, s[60:63], s98 offen offset:3072 sc1
    v_lshlrev_b32 v112, 16, v116
    v_and_b32 v113, s3, v116
    v_lshlrev_b32 v114, 16, v117
    v_and_b32_e64 v115, s3, v117
    v_bfe_u32 v8, v1, 3, 2
    v_mov_b32 v9, 0xbfb8aa3b
    v_mfma_f32_32x32x16_bf16 v[16:31], v[160:163], a[16:19], v[16:31]
    v_cmp_eq_u32 vcc, 0, v8
    s_nop 1
    v_cndmask_b32_e64 v9, v9, 1.0, vcc
    v_mov_b32 v10, 0xbf317218
    v_cmp_eq_u32 vcc, 3, v8
    s_nop 1
    v_cndmask_b32 v9, v9, v10, vcc
    v_mul_f32 v112, v9, v112
    s_add_u32 s98, s98, 4096
    s_waitcnt vmcnt(6)
    v_mfma_f32_32x32x16_bf16 v[32:47], v[172:175], a[20:23], v[32:47]
    v_mul_f32 v113, v9, v113
    v_mul_f32 v114, v9, v114
    v_mul_f32 v115, v9, v115
    s_lshl_b32 s88, s68, 12
    s_add_u32 s88, s88, 147456
    v_mfma_f32_32x32x16_bf16 v[16:31], v[168:171], a[20:23], v[16:31]
    buffer_load_dwordx4 a[48:51], v2, s[60:63], s98 offen offset:0 sc1
    v_add_u32 v8, s88, v2
    v_lshrrev_b32 v9, 5, v1
    v_lshlrev_b32 v9, 4, v9
    v_add_u32 v9, s88, v9
    s_waitcnt vmcnt(6)
    v_mfma_f32_32x32x16_bf16 v[32:47], v[180:183], a[24:27], v[32:47]
    buffer_load_dwordx4 a[52:55], v2, s[60:63], s98 offen offset:1024 sc1
    ds_write_b128 v8, v[112:115]
    v_mfma_f32_32x32x16_bf16 v[16:31], v[176:179], a[24:27], v[16:31]
    buffer_load_dwordx4 a[56:59], v2, s[60:63], s98 offen offset:2048 sc1
    ds_read_b128 v[64:67], v9 offset:0
    ds_read_b128 v[96:99], v9 offset:128
    s_waitcnt vmcnt(7)
    v_mfma_f32_32x32x16_bf16 v[32:47], v[188:191], a[28:31], v[32:47]
    buffer_load_dwordx4 a[60:63], v2, s[60:63], s98 offen offset:3072 sc1
    ds_read_b128 v[80:83], v9 offset:256
    ds_read_b128 a[240:243], v9 offset:384
    v_mfma_f32_32x32x16_bf16 v[16:31], v[184:187], a[28:31], v[16:31]
    ds_read_b128 v[68:71], v9 offset:32
    ds_read_b128 v[100:103], v9 offset:160
    ds_read_b128 v[84:87], v9 offset:288
    ds_read_b128 a[244:247], v9 offset:416
    s_waitcnt vmcnt(7)
    v_mfma_f32_32x32x16_bf16 v[32:47], v[196:199], a[32:35], v[32:47]
    ds_read_b128 v[72:75], v9 offset:64
    s_lshl_b32 s4, s22, 2
    s_add_u32 s4, s4, s68
    s_mul_i32 s4, s4, 88064
    s_add_u32 s4, s4, s12
    s_lshl_b32 s5, s68, 11
    s_add_u32 m0, s5, 73728
    v_mfma_f32_32x32x16_bf16 v[16:31], v[192:195], a[32:35], v[16:31]
    buffer_load_dwordx4 v13, s[44:47], s4 offen lds
    ds_read_b128 v[104:107], v9 offset:192
    ds_read_b128 v[88:91], v9 offset:320
    s_add_u32 m0, s5, 81856
    s_waitcnt vmcnt(7)
    v_mfma_f32_32x32x16_bf16 v[32:47], v[204:207], a[36:39], v[32:47]
    buffer_load_dwordx4 v13, s[44:47], s4 offen offset:64 lds
    ds_read_b128 a[248:251], v9 offset:448
    ds_read_b128 v[76:79], v9 offset:96
    s_add_u32 m0, s5, 89984
    v_mfma_f32_32x32x16_bf16 v[16:31], v[200:203], a[36:39], v[16:31]
    buffer_load_dwordx4 v13, s[44:47], s4 offen offset:128 lds
    ds_read_b128 v[108:111], v9 offset:224
    s_add_u32 s4, s4, 44032
    s_add_u32 m0, s5, 74752
    s_waitcnt vmcnt(8)
    v_mfma_f32_32x32x16_bf16 v[32:47], v[212:215], a[40:43], v[32:47]
    buffer_load_dwordx4 v13, s[44:47], s4 offen lds
    ds_read_b128 v[92:95], v9 offset:352
    ds_read_b128 a[252:255], v9 offset:480
    v_xor_b32 v9, 8192, v8
    s_add_u32 m0, s5, 82880
    v_mfma_f32_32x32x16_bf16 v[16:31], v[208:211], a[40:43], v[16:31]
    buffer_load_dwordx4 v13, s[44:47], s4 offen offset:64 lds
    v_accvgpr_read_b32 v120, a224
    v_accvgpr_read_b32 v121, a225
    v_accvgpr_read_b32 v122, a226
    v_accvgpr_read_b32 v123, a227
    v_accvgpr_read_b32 v124, a228
    s_add_u32 m0, s5, 91008
    s_waitcnt vmcnt(9)
    v_mfma_f32_32x32x16_bf16 v[32:47], v[220:223], a[44:47], v[32:47]
    buffer_load_dwordx4 v13, s[44:47], s4 offen offset:128 lds
    v_accvgpr_read_b32 v125, a229
    v_accvgpr_read_b32 v126, a230
    v_accvgpr_read_b32 v127, a231
    s_lshl_b32 s4, s23, 2
    s_add_u32 s4, s4, s68
    s_mul_i32 s4, s4, 88064
    v_mfma_f32_32x32x16_bf16 v[16:31], v[216:219], a[44:47], v[16:31]
    v_accvgpr_read_b32 v12, a223
    v_mov_b32 v11, 0xffffff00
    s_add_u32 s4, s4, s12
    s_lshl_b32 s5, s68, 11
    s_add_u32 m0, s5, 98304
    s_add_u32 s88, s99, s77
    s_lshl_b32 s88, s88, 12
    s_waitcnt vmcnt(9)
    v_mfma_f32_32x32x16_bf16 v[32:47], v[228:231], a[48:51], v[32:47]
    buffer_load_dwordx4 v6, s[40:43], s4 offen lds
    s_add_u32 m0, s5, 114624
    s_add_u32 s88, s88, s74
    s_add_u32 s88, s88, 4096
    s_lshl_b32 s89, s72, 9
    s_add_u32 s89, s89, s88
    v_mfma_f32_32x32x16_bf16 v[16:31], v[224:227], a[48:51], v[16:31]
    buffer_load_dwordx4 v6, s[40:43], s4 offen offset:64 lds
    s_add_u32 m0, s5, 130944
    s_lshl_b32 s90, s78, 3
    s_add_u32 s89, s89, s90
    s_waitcnt vmcnt(10)
    v_mfma_f32_32x32x16_bf16 v[32:47], v[236:239], a[52:55], v[32:47]
    buffer_load_dwordx4 v6, s[40:43], s4 offen offset:128 lds
    s_add_u32 m0, s5, 106496
    v_mfma_f32_32x32x16_bf16 v[16:31], v[232:235], a[52:55], v[16:31]
    buffer_load_dwordx4 v13, s[44:47], s4 offen lds
    s_add_u32 m0, s5, 122816
    s_waitcnt vmcnt(11)
    v_mfma_f32_32x32x16_bf16 v[32:47], v[244:247], a[56:59], v[32:47]
    buffer_load_dwordx4 v13, s[44:47], s4 offen offset:64 lds
    s_add_u32 m0, s5, 139136
    v_mfma_f32_32x32x16_bf16 v[16:31], v[240:243], a[56:59], v[16:31]
    buffer_load_dwordx4 v13, s[44:47], s4 offen offset:128 lds
    s_add_u32 s4, s4, 44032
    s_waitcnt vmcnt(12)
    v_mfma_f32_32x32x16_bf16 v[32:47], v[252:255], a[60:63], v[32:47]
    v_mfma_f32_32x32x16_bf16 v[16:31], v[248:251], a[60:63], v[16:31]
    v_lshlrev_b32 v240, 16, v120
    v_and_b32 v241, s3, v120
    v_lshlrev_b32 v242, 16, v121
    v_and_b32 v243, s3, v121
    v_lshlrev_b32 v244, 16, v122
    v_and_b32 v245, s3, v122
    v_lshlrev_b32 v246, 16, v123
    v_and_b32 v247, s3, v123
    s_nop 2
    ds_write_b128 v8, v[32:35] offset:0
    ds_write_b128 v8, v[36:39] offset:1024
    ds_write_b128 v8, v[40:43] offset:2048
    ds_write_b128 v8, v[44:47] offset:3072
    v_lshlrev_b32 v248, 16, v124
    v_and_b32 v249, s3, v124
    v_lshlrev_b32 v250, 16, v125
    v_and_b32 v251, s3, v125
    v_lshlrev_b32 v252, 16, v126
    v_and_b32 v253, s3, v126
    v_lshlrev_b32 v254, 16, v127
    v_and_b32 v255, s3, v127
    s_waitcnt lgkmcnt(0)
    s_barrier
    s_nop 0
    ds_read_b128 v[48:51], v9 offset:0
    ds_read_b128 v[52:55], v9 offset:1024
    ds_read_b128 v[56:59], v9 offset:2048
    ds_read_b128 v[60:63], v9 offset:3072
    v_pk_fma_f32 v[240:241], v[16:17], v[64:65], v[240:241]
    v_pk_fma_f32 v[242:243], v[18:19], v[66:67], v[242:243]
    v_pk_fma_f32 v[244:245], v[20:21], v[68:69], v[244:245]
    v_pk_fma_f32 v[246:247], v[22:23], v[70:71], v[246:247]
    v_pk_fma_f32 v[248:249], v[24:25], v[72:73], v[248:249]
    v_pk_fma_f32 v[250:251], v[26:27], v[74:75], v[250:251]
    v_pk_fma_f32 v[252:253], v[28:29], v[76:77], v[252:253]
    v_pk_fma_f32 v[254:255], v[30:31], v[78:79], v[254:255]
    s_waitcnt lgkmcnt(3)
    v_pk_fma_f32 v[16:17], v[48:49], v[64:65], v[240:241]
    v_pk_fma_f32 v[18:19], v[50:51], v[66:67], v[242:243]
    v_cvt_pk_bf16_f32 v32, v16, v17
    v_cvt_pk_bf16_f32 v33, v18, v19
    s_waitcnt lgkmcnt(2)
    v_pk_fma_f32 v[20:21], v[52:53], v[68:69], v[244:245]
    v_pk_fma_f32 v[22:23], v[54:55], v[70:71], v[246:247]
    v_cvt_pk_bf16_f32 v34, v20, v21
    v_cvt_pk_bf16_f32 v35, v22, v23
    s_waitcnt lgkmcnt(1)
    v_pk_fma_f32 v[24:25], v[56:57], v[72:73], v[248:249]
    v_pk_fma_f32 v[26:27], v[58:59], v[74:75], v[250:251]
    v_cvt_pk_bf16_f32 v36, v24, v25
    v_cvt_pk_bf16_f32 v37, v26, v27
    s_waitcnt lgkmcnt(0)
    v_pk_fma_f32 v[28:29], v[60:61], v[76:77], v[252:253]
    v_pk_fma_f32 v[30:31], v[62:63], v[78:79], v[254:255]
    v_cvt_pk_bf16_f32 v38, v28, v29
    v_cvt_pk_bf16_f32 v39, v30, v31
    v_dot2_f32_bf16 v40, v32, s1, 0
    v_dot2_f32_bf16 v41, v32, v32, 0
    v_dot2_f32_bf16 v40, v33, s1, v40
    v_dot2_f32_bf16 v41, v33, v33, v41
    v_dot2_f32_bf16 v40, v34, s1, v40
    v_dot2_f32_bf16 v41, v34, v34, v41
    v_dot2_f32_bf16 v40, v35, s1, v40
    v_dot2_f32_bf16 v41, v35, v35, v41
    v_dot2_f32_bf16 v40, v36, s1, v40
    v_dot2_f32_bf16 v41, v36, v36, v41
    v_dot2_f32_bf16 v40, v37, s1, v40
    v_dot2_f32_bf16 v41, v37, v37, v41
    v_dot2_f32_bf16 v40, v38, s1, v40
    v_dot2_f32_bf16 v41, v38, v38, v41
    v_dot2_f32_bf16 v40, v39, s1, v40
    v_dot2_f32_bf16 v41, v39, v39, v41
    v_lshlrev_b32 v240, 16, v32
    v_and_b32 v241, s3, v32
    v_lshlrev_b32 v242, 16, v33
    v_mov_b32 v42, v40
    v_mov_b32 v43, v41
    v_and_b32 v243, s3, v33
    v_permlane32_swap_b32 v40, v42
    v_permlane32_swap_b32 v41, v43
    v_pk_add_f32 v[40:41], v[40:41], v[42:43]
    v_and_or_b32 v40, v40, v11, s80
    v_and_or_b32 v41, v41, v11, s81
    s_mov_b64 exec, 0xffffffff
    s_cmp_eq_u32 s76, 0
    s_cbranch_scc1 L_slow_19
    buffer_store_dwordx2 v[40:41], v2, s[64:67], s89 offen
L_join_20:
    s_mov_b64 exec, -1
    s_lshl_b32 s4, s23, 2
    s_add_u32 s4, s4, s68
    s_mul_i32 s4, s4, 88064
    s_add_u32 s4, s4, s12
    s_lshl_b32 s5, s68, 11
    s_add_u32 s4, s4, 44032
    s_add_u32 m0, s5, 99328
    s_nop 0
    buffer_load_dwordx4 v6, s[40:43], s4 offen lds
    s_add_u32 m0, s5, 115648
    s_nop 0
    buffer_load_dwordx4 v6, s[40:43], s4 offen offset:64 lds
    s_add_u32 m0, s5, 131968
    s_nop 0
    buffer_load_dwordx4 v6, s[40:43], s4 offen offset:128 lds
    s_add_u32 m0, s5, 107520
    s_nop 0
    buffer_load_dwordx4 v13, s[44:47], s4 offen lds
    s_add_u32 m0, s5, 123840
    s_nop 0
    buffer_load_dwordx4 v13, s[44:47], s4 offen offset:64 lds
    s_add_u32 m0, s5, 140160
    s_nop 0
    buffer_load_dwordx4 v13, s[44:47], s4 offen offset:128 lds
    v_lshlrev_b32 v244, 16, v34
    v_and_b32 v245, s3, v34
    v_lshlrev_b32 v246, 16, v35
    v_and_b32 v247, s3, v35
    v_lshlrev_b32 v248, 16, v36
    v_and_b32 v249, s3, v36
    v_lshlrev_b32 v250, 16, v37
    v_and_b32 v251, s3, v37
    v_lshlrev_b32 v252, 16, v38
    v_and_b32 v253, s3, v38
    v_lshlrev_b32 v254, 16, v39
    v_and_b32 v255, s3, v39
    s_mov_b32 s96, 0
    s_and_b32 s90, s75, 0xffff
    s_mul_i32 s90, s90, 0x10001
    s_mov_b32 s100, 0x0c0c0400
    s_mov_b32 s101, 0x04000c0c
    s_lshl_b32 s89, s72, 12
    s_lshl_b32 s91, s78, 11
    s_add_u32 s89, s89, s91
    s_add_u32 s89, s89, s10
L_st:
    buffer_load_dwordx4 v[128:131], v12, s[64:67], s88 offen offset:0 sc1
    buffer_load_dwordx4 v[132:135], v12, s[64:67], s88 offen offset:512 sc1
    buffer_load_dwordx4 v[136:139], v12, s[64:67], s88 offen offset:1024 sc1
    buffer_load_dwordx4 v[140:143], v12, s[64:67], s88 offen offset:1536 sc1
    s_add_u32 s96, s96, 1
    s_waitcnt vmcnt(3)
    v_perm_b32 v144, v129, v128, s100
    v_perm_b32 v9, v131, v130, s101
    v_bitop3_b32 v144, v144, v9, s90 bitop3:0x56
    v_and_b32 v128, v11, v128
    v_and_b32 v129, v11, v129
    v_and_b32 v130, v11, v130
    v_and_b32 v131, v11, v131
    v_pk_add_f32 v[128:129], v[128:129], v[130:131]
    s_waitcnt vmcnt(2)
    v_perm_b32 v145, v133, v132, s100
    v_perm_b32 v9, v135, v134, s101
    v_bitop3_b32 v145, v145, v9, s90 bitop3:0x56
    v_and_b32 v132, v11, v132
    v_and_b32 v133, v11, v133
    v_and_b32 v134, v11, v134
    v_and_b32_e64 v135, v11, v135
    v_pk_add_f32 v[132:133], v[132:133], v[134:135]
    v_pk_add_f32 v[128:129], v[128:129], v[132:133]
    s_waitcnt vmcnt(1)
    v_perm_b32 v146, v137, v136, s100
    v_perm_b32 v9, v139, v138, s101
    v_bitop3_b32 v146, v146, v9, s90 bitop3:0x56
    v_and_b32 v136, v11, v136
    v_and_b32 v137, v11, v137
    v_and_b32 v138, v11, v138
    v_and_b32_e64 v139, v11, v139
    v_pk_add_f32 v[136:137], v[136:137], v[138:139]
    v_pk_add_f32 v[128:129], v[128:129], v[136:137]
    s_waitcnt vmcnt(0)
    v_perm_b32 v147, v141, v140, s100
    v_perm_b32 v9, v143, v142, s101
    v_bitop3_b32 v147, v147, v9, s90 bitop3:0x56
    v_and_b32 v140, v11, v140
    v_and_b32 v141, v11, v141
    v_and_b32 v142, v11, v142
    v_and_b32_e64 v143, v11, v143
    v_pk_add_f32 v[140:141], v[140:141], v[142:143]
    v_pk_add_f32 v[128:129], v[128:129], v[140:141]
    v_or3_b32 v9, v144, v145, v146
    v_or_b32 v9, v9, v147
    v_mov_b32 v130, v128
    v_mov_b32 v131, v129
    v_cmp_ne_u32 vcc, 0, v9
    s_cbranch_vccz L_std
    s_cmp_lt_u32 s96, 0x80000
    s_cbranch_scc1 L_st
L_std:
    v_permlane32_swap_b32 v128, v130
    v_permlane32_swap_b32 v129, v131
    v_add_f32 v128, v128, v130
    v_add_f32 v130, v129, v131
    v_mul_f32 v128, 0x3b000000, v128
    v_mul_f32 v130, 0x3b000000, v130
    v_fma_f32 v130, -v128, v128, v130
    v_max_f32_e64 v130, 0, v130
    v_add_f32 v130, 0x3727c5ac, v130
    v_rsq_f32 v130, v130
    s_nop 0
    v_mul_f32_e64 v128, -v128, v130
    v_pk_fma_f32 v[16:17], v[240:241], v[130:131], v[128:129] op_sel_hi:[1,0,0]
    v_pk_fma_f32 v[18:19], v[242:243], v[130:131], v[128:129] op_sel_hi:[1,0,0]
    v_pk_fma_f32 v[20:21], v[244:245], v[130:131], v[128:129] op_sel_hi:[1,0,0]
    v_pk_fma_f32 v[22:23], v[246:247], v[130:131], v[128:129] op_sel_hi:[1,0,0]
    v_pk_fma_f32 v[16:17], v[16:17], v[80:81], v[96:97]
    v_pk_fma_f32 v[18:19], v[18:19], v[82:83], v[98:99]
    v_pk_fma_f32 v[20:21], v[20:21], v[84:85], v[100:101]
    v_pk_fma_f32 v[22:23], v[22:23], v[86:87], v[102:103]
    v_cvt_pk_bf16_f32 v32, v16, v17
    v_cvt_pk_bf16_f32 v33, v18, v19
    v_cvt_pk_bf16_f32 v34, v20, v21
    v_cvt_pk_bf16_f32 v35, v22, v23
    s_cmp_eq_u32 s76, 0
    s_cbranch_scc1 L_slow_21
    buffer_store_dwordx4 v[32:35], v2, s[60:63], s89 offen offset:0
L_join_22:
    v_pk_fma_f32 v[24:25], v[248:249], v[130:131], v[128:129] op_sel_hi:[1,0,0]
    v_pk_fma_f32 v[26:27], v[250:251], v[130:131], v[128:129] op_sel_hi:[1,0,0]
    v_pk_fma_f32 v[28:29], v[252:253], v[130:131], v[128:129] op_sel_hi:[1,0,0]
    v_pk_fma_f32 v[30:31], v[254:255], v[130:131], v[128:129] op_sel_hi:[1,0,0]
    v_pk_fma_f32 v[24:25], v[24:25], v[88:89], v[104:105]
    v_pk_fma_f32 v[26:27], v[26:27], v[90:91], v[106:107]
    v_pk_fma_f32 v[28:29], v[28:29], v[92:93], v[108:109]
    v_pk_fma_f32 v[30:31], v[30:31], v[94:95], v[110:111]
    v_cvt_pk_bf16_f32 v36, v24, v25
    v_cvt_pk_bf16_f32 v37, v26, v27
    v_cvt_pk_bf16_f32 v38, v28, v29
    v_cvt_pk_bf16_f32 v39, v30, v31
    s_cmp_eq_u32 s76, 0
    s_cbranch_scc1 L_slow_23
    buffer_store_dwordx4 v[36:39], v2, s[60:63], s89 offen offset:1024
L_join_24:
    s_mov_b32 s100, 0x55555555
    s_mov_b32 s101, 0
    s_lshl_b32 s88, s78, 5
    s_add_u32 s88, s88, s77
    s_lshl_b64 s[92:93], s[100:101], s88
    v_accvgpr_read_b32 v152, a221
    v_xor_b32_e64 v153, 32, v152
    v_add_u32 v154, 49152, v152
    v_add_u32 v155, 49152, v153
    v_add_u32 v156, 98304, v152
    v_add_u32 v157, 98304, v153
    v_bfe_u32 v8, v1, 4, 1
    v_lshl_add_u32 v154, v8, 14, v154
    v_lshl_add_u32 v155, v8, 14, v155
    s_and_b32 s98, s79, 0xffffff80
    s_lshl_b32 s88, s68, 5
    s_add_u32 s98, s98, s88
    s_lshl_b32 s98, s98, 10
    s_lshl_b32 s91, s21, 13
    s_add_u32 s91, s91, s98
    s_lshl_b32 s89, s73, 11
    s_add_u32 s89, s89, s98
    s_cmp_lt_u32 s73, 14
    s_cselect_b32 s16, s89, 0x7f000000
    s_mov_b32 s89, 0x10000000
    s_mov_b32 s90, 0x01000000
    s_cmp_eq_u32 s78, 0
    s_cselect_b32 s100, 0x01111111, s89
    s_cselect_b32 s101, s90, 0x01111111
    s_add_u32 s88, s99, s77
    s_lshl_b64 s[54:55], s[100:101], s88
    v_accvgpr_read_b32 v12, a220
    s_mul_i32 s88, s78, 24576
    s_add_u32 s88, s88, 49152
    v_add_u32 v160, s88, v12
    v_xor_b32 v161, 64, v160
    s_cmp_eq_u32 s78, 0
    s_cselect_b32 s88, 98304, 0
    v_add_u32 v162, s88, v12
    v_xor_b32 v163, 64, v162
    s_lshl_b32 s88, s78, 13
    s_add_u32 s88, s88, 147456
    v_add_u32 v164, s88, v12
    v_xor_b32_e64 v165, 64, v164
    s_mul_i32 s53, s78, 28672
    s_add_u32 s53, s53, s27
    s_add_u32 s53, s53, 32768
    s_mul_i32 s26, s78, 14336
    s_add_u32 s26, s26, s10
    s_mul_i32 s17, s78, 688128
    s_lshl_b32 s88, s77, 13
    s_add_u32 s17, s17, s88
    s_add_u32 s17, s17, s11
    s_lshl_b32 s88, s77, 10
    s_mul_i32 s18, s78, 24576
    s_add_u32 s18, s18, s88
    s_mul_i32 s19, s78, 8192
    s_add_u32 s19, s19, s88
    s_mul_i32 s20, s78, 4294868992
    s_add_u32 s20, s20, s88
    v_add_u32 v166, 16384, v4
    v_add_u32 v167, 32768, v4
    v_mov_b32 v7, s75
    s_waitcnt vmcnt(0)
    s_mov_b64 exec, 1
    s_cmp_eq_u32 s76, 0
    s_cbranch_scc1 L_slow_25
    buffer_store_dword v7, off, s[64:67], s8 offset:256
L_join_26:
    s_mov_b64 exec, -1
    s_lshl_b32 s88, s68, 8
    s_add_u32 s88, s88, s2
    s_cmp_eq_u32 s88, 120
    s_cbranch_scc1 L_epoch
L_epret:
    s_mov_b32 s96, 0
L_poll_27:
    buffer_load_dword v7, v3, s[64:67], s74 offen offset:256 sc1
    s_add_u32 s96, s96, 1
    s_waitcnt vmcnt(0)
    v_cmp_eq_u32 vcc, s75, v7
    s_nop 0
    s_and_b64 s[94:95], vcc, s[92:93]
    s_cmp_eq_u64 s[94:95], s[92:93]
    s_cbranch_scc1 L_pd_28
    s_cmp_lt_u32 s96, 0x80000
    s_cbranch_scc1 L_poll_27
L_pd_28:
    buffer_load_dwordx4 a[0:3], v2, s[60:63], s91 offen offset:0 sc1
    buffer_load_dwordx4 a[4:7], v2, s[60:63], s91 offen offset:1024 sc1
    buffer_load_dwordx4 a[8:11], v2, s[60:63], s91 offen offset:2048 sc1
    buffer_load_dwordx4 a[12:15], v2, s[60:63], s91 offen offset:3072 sc1
    s_barrier
    s_mov_b32 s100, 0x11111111
    s_mov_b32 s101, 0x11111111
    s_lshl_b64 s[92:93], s[100:101], s68
    s_nop 0
    ds_read_b64_tr_b16 v[112:113], v152 offset:0
    ds_read_b64_tr_b16 v[114:115], v152 offset:512
    ds_read_b64_tr_b16 v[116:117], v153 offset:0
    ds_read_b64_tr_b16 v[118:119], v153 offset:512
    ds_read_b64_tr_b16 v[120:121], v152 offset:16384
    ds_read_b64_tr_b16 v[122:123], v152 offset:16896
    ds_read_b64_tr_b16 v[124:125], v153 offset:16384
    ds_read_b64_tr_b16 v[126:127], v153 offset:16896
    ds_read_b64_tr_b16 v[128:129], v152 offset:32768
    ds_read_b64_tr_b16 v[130:131], v152 offset:33280
    ds_read_b64_tr_b16 v[132:133], v153 offset:32768
    ds_read_b64_tr_b16 v[134:135], v153 offset:33280
    s_waitcnt vmcnt(3) lgkmcnt(10)
    v_mfma_f32_32x32x16_bf16 v[16:31], v[112:115], a[0:3], 0
    ds_read_b64_tr_b16 v[136:137], v152 offset:1024
    ds_read_b64_tr_b16 v[138:139], v152 offset:1536
    s_add_u32 s91, s91, 4096
    s_waitcnt lgkmcnt(10)
    v_mfma_f32_32x32x16_bf16 v[32:47], v[116:119], a[0:3], 0
    ds_read_b64_tr_b16 v[140:141], v153 offset:1024
    ds_read_b64_tr_b16 v[142:143], v153 offset:1536
    buffer_load_dwordx4 a[16:19], v2, s[60:63], s91 offen offset:0 sc1
    s_waitcnt lgkmcnt(8)
    v_mfma_f32_32x32x16_bf16 v[48:63], v[120:123], a[0:3], 0
    ds_read_b64_tr_b16 v[112:113], v152 offset:17408
    ds_read_b64_tr_b16 v[114:115], v152 offset:17920
    buffer_load_dwordx4 a[20:23], v2, s[60:63], s91 offen offset:1024 sc1
    v_mfma_f32_32x32x16_bf16 v[64:79], v[124:127], a[0:3], 0
    ds_read_b64_tr_b16 v[116:117], v153 offset:17408
    ds_read_b64_tr_b16 v[118:119], v153 offset:17920
    buffer_load_dwordx4 a[24:27], v2, s[60:63], s91 offen offset:2048 sc1
    s_waitcnt lgkmcnt(6)
    v_mfma_f32_32x32x16_bf16 v[80:95], v[128:131], a[0:3], 0
    ds_read_b64_tr_b16 v[120:121], v152 offset:33792
    ds_read_b64_tr_b16 v[122:123], v152 offset:34304
    buffer_load_dwordx4 a[28:31], v2, s[60:63], s91 offen offset:3072 sc1
    v_mfma_f32_32x32x16_bf16 v[96:111], v[132:135], a[0:3], 0
    ds_read_b64_tr_b16 v[124:125], v153 offset:33792
    ds_read_b64_tr_b16 v[126:127], v153 offset:34304
    s_lshl_b32 s91, s22, 13
    s_waitcnt vmcnt(6)
    v_mfma_f32_32x32x16_bf16 v[16:31], v[136:139], a[4:7], v[16:31]
    ds_read_b64_tr_b16 v[128:129], v152 offset:2048
    ds_read_b64_tr_b16 v[130:131], v152 offset:2560
    s_add_u32 s91, s91, s98
    s_waitcnt lgkmcnt(6)
    v_mfma_f32_32x32x16_bf16 v[32:47], v[140:143], a[4:7], v[32:47]
    ds_read_b64_tr_b16 v[132:133], v153 offset:2048
    ds_read_b64_tr_b16 v[134:135], v153 offset:2560
    buffer_load_dwordx4 a[32:35], v2, s[60:63], s91 offen offset:0 sc1
    v_mfma_f32_32x32x16_bf16 v[48:63], v[112:115], a[4:7], v[48:63]
    ds_read_b64_tr_b16 v[136:137], v152 offset:18432
    ds_read_b64_tr_b16 v[138:139], v152 offset:18944
    buffer_load_dwordx4 a[36:39], v2, s[60:63], s91 offen offset:1024 sc1
    v_mfma_f32_32x32x16_bf16 v[64:79], v[116:119], a[4:7], v[64:79]
    ds_read_b64_tr_b16 v[140:141], v153 offset:18432
    ds_read_b64_tr_b16 v[142:143], v153 offset:18944
    buffer_load_dwordx4 a[40:43], v2, s[60:63], s91 offen offset:2048 sc1
    s_waitcnt lgkmcnt(6)
    v_mfma_f32_32x32x16_bf16 v[80:95], v[120:123], a[4:7], v[80:95]
    ds_read_b64_tr_b16 v[112:113], v152 offset:34816
    ds_read_b64_tr_b16 v[114:115], v152 offset:35328
    buffer_load_dwordx4 a[44:47], v2, s[60:63], s91 offen offset:3072 sc1
    v_mfma_f32_32x32x16_bf16 v[96:111], v[124:127], a[4:7], v[96:111]
    ds_read_b64_tr_b16 v[116:117], v153 offset:34816
    ds_read_b64_tr_b16 v[118:119], v153 offset:35328
    s_add_u32 s91, s91, 4096
    s_waitcnt vmcnt(9)
    v_mfma_f32_32x32x16_bf16 v[16:31], v[128:131], a[8:11], v[16:31]
    ds_read_b64_tr_b16 v[120:121], v152 offset:3072
    ds_read_b64_tr_b16 v[122:123], v152 offset:3584
    buffer_load_dwordx4 a[48:51], v2, s[60:63], s91 offen offset:0 sc1
    s_waitcnt lgkmcnt(6)
    v_mfma_f32_32x32x16_bf16 v[32:47], v[132:135], a[8:11], v[32:47]
    ds_read_b64_tr_b16 v[124:125], v153 offset:3072
    ds_read_b64_tr_b16 v[126:127], v153 offset:3584
    buffer_load_dwordx4 a[52:55], v2, s[60:63], s91 offen offset:1024 sc1
    v_mfma_f32_32x32x16_bf16 v[48:63], v[136:139], a[8:11], v[48:63]
    ds_read_b64_tr_b16 v[128:129], v152 offset:19456
    ds_read_b64_tr_b16 v[130:131], v152 offset:19968
    buffer_load_dwordx4 a[56:59], v2, s[60:63], s91 offen offset:2048 sc1
    v_mfma_f32_32x32x16_bf16 v[64:79], v[140:143], a[8:11], v[64:79]
    ds_read_b64_tr_b16 v[132:133], v153 offset:19456
    ds_read_b64_tr_b16 v[134:135], v153 offset:19968
    buffer_load_dwordx4 a[60:63], v2, s[60:63], s91 offen offset:3072 sc1
    s_waitcnt lgkmcnt(6)
    v_mfma_f32_32x32x16_bf16 v[80:95], v[112:115], a[8:11], v[80:95]
    ds_read_b64_tr_b16 v[136:137], v152 offset:35840
    ds_read_b64_tr_b16 v[138:139], v152 offset:36352
    s_lshl_b32 s91, s23, 13
    v_mfma_f32_32x32x16_bf16 v[96:111], v[116:119], a[8:11], v[96:111]
    ds_read_b64_tr_b16 v[140:141], v153 offset:35840
    ds_read_b64_tr_b16 v[142:143], v153 offset:36352
    s_add_u32 s91, s91, s98
    s_waitcnt vmcnt(12)
    v_mfma_f32_32x32x16_bf16 v[16:31], v[120:123], a[12:15], v[16:31]
    ds_read_b64_tr_b16 v[112:113], v152 offset:4096
    ds_read_b64_tr_b16 v[114:115], v152 offset:4608
    buffer_load_dwordx4 a[64:67], v2, s[60:63], s91 offen offset:0 sc1
    s_waitcnt lgkmcnt(6)
    v_mfma_f32_32x32x16_bf16 v[32:47], v[124:127], a[12:15], v[32:47]
    ds_read_b64_tr_b16 v[116:117], v153 offset:4096
    ds_read_b64_tr_b16 v[118:119], v153 offset:4608
    v_mfma_f32_32x32x16_bf16 v[48:63], v[128:131], a[12:15], v[48:63]
    ds_read_b64_tr_b16 v[120:121], v152 offset:20480
    ds_read_b64_tr_b16 v[122:123], v152 offset:20992
    buffer_load_dwordx4 a[68:71], v2, s[60:63], s91 offen offset:1024 sc1
    v_mfma_f32_32x32x16_bf16 v[64:79], v[132:135], a[12:15], v[64:79]
    ds_read_b64_tr_b16 v[124:125], v153 offset:20480
    ds_read_b64_tr_b16 v[126:127], v153 offset:20992
    buffer_load_dwordx4 a[72:75], v2, s[60:63], s91 offen offset:2048 sc1
    s_waitcnt lgkmcnt(6)
    v_mfma_f32_32x32x16_bf16 v[80:95], v[136:139], a[12:15], v[80:95]
    ds_read_b64_tr_b16 v[128:129], v152 offset:36864
    ds_read_b64_tr_b16 v[130:131], v152 offset:37376
    buffer_load_dwordx4 a[76:79], v2, s[60:63], s91 offen offset:3072 sc1
    v_mfma_f32_32x32x16_bf16 v[96:111], v[140:143], a[12:15], v[96:111]
    ds_read_b64_tr_b16 v[132:133], v153 offset:36864
    ds_read_b64_tr_b16 v[134:135], v153 offset:37376
    s_add_u32 s91, s91, 4096
    s_waitcnt vmcnt(15)
    v_mfma_f32_32x32x16_bf16 v[16:31], v[112:115], a[16:19], v[16:31]
    ds_read_b64_tr_b16 v[136:137], v152 offset:5120
    ds_read_b64_tr_b16 v[138:139], v152 offset:5632
    buffer_load_dwordx4 a[80:83], v2, s[60:63], s91 offen offset:0 sc1
    s_waitcnt lgkmcnt(6)
    v_mfma_f32_32x32x16_bf16 v[32:47], v[116:119], a[16:19], v[32:47]
    ds_read_b64_tr_b16 v[140:141], v153 offset:5120
    ds_read_b64_tr_b16 v[142:143], v153 offset:5632
    buffer_load_dwordx4 a[84:87], v2, s[60:63], s91 offen offset:1024 sc1
    v_mfma_f32_32x32x16_bf16 v[48:63], v[120:123], a[16:19], v[48:63]
    ds_read_b64_tr_b16 v[112:113], v152 offset:21504
    ds_read_b64_tr_b16 v[114:115], v152 offset:22016
    buffer_load_dwordx4 a[88:91], v2, s[60:63], s91 offen offset:2048 sc1
    v_mfma_f32_32x32x16_bf16 v[64:79], v[124:127], a[16:19], v[64:79]
    ds_read_b64_tr_b16 v[116:117], v153 offset:21504
    ds_read_b64_tr_b16 v[118:119], v153 offset:22016
    buffer_load_dwordx4 a[92:95], v2, s[60:63], s91 offen offset:3072 sc1
    s_waitcnt lgkmcnt(6)
    v_mfma_f32_32x32x16_bf16 v[80:95], v[128:131], a[16:19], v[80:95]
    ds_read_b64_tr_b16 v[120:121], v152 offset:37888
    ds_read_b64_tr_b16 v[122:123], v152 offset:38400
    s_lshl_b32 s91, s24, 13
    v_mfma_f32_32x32x16_bf16 v[96:111], v[132:135], a[16:19], v[96:111]
    ds_read_b64_tr_b16 v[124:125], v153 offset:37888
    ds_read_b64_tr_b16 v[126:127], v153 offset:38400
    s_add_u32 s91, s91, s98
    s_waitcnt vmcnt(18)
    v_mfma_f32_32x32x16_bf16 v[16:31], v[136:139], a[20:23], v[16:31]
    ds_read_b64_tr_b16 v[128:129], v152 offset:6144
    ds_read_b64_tr_b16 v[130:131], v152 offset:6656
    buffer_load_dwordx4 a[96:99], v2, s[60:63], s91 offen offset:0 sc1
    s_waitcnt lgkmcnt(6)
    v_mfma_f32_32x32x16_bf16 v[32:47], v[140:143], a[20:23], v[32:47]
    ds_read_b64_tr_b16 v[132:133], v153 offset:6144
    ds_read_b64_tr_b16 v[134:135], v153 offset:6656
    buffer_load_dwordx4 a[100:103], v2, s[60:63], s91 offen offset:1024 sc1
    v_mfma_f32_32x32x16_bf16 v[48:63], v[112:115], a[20:23], v[48:63]
    ds_read_b64_tr_b16 v[136:137], v152 offset:22528
    ds_read_b64_tr_b16 v[138:139], v152 offset:23040
    buffer_load_dwordx4 a[104:107], v2, s[60:63], s91 offen offset:2048 sc1
    v_mfma_f32_32x32x16_bf16 v[64:79], v[116:119], a[20:23], v[64:79]
    ds_read_b64_tr_b16 v[140:141], v153 offset:22528
    ds_read_b64_tr_b16 v[142:143], v153 offset:23040
    buffer_load_dwordx4 a[108:111], v2, s[60:63], s91 offen offset:3072 sc1
    s_waitcnt lgkmcnt(6)
    v_mfma_f32_32x32x16_bf16 v[80:95], v[120:123], a[20:23], v[80:95]
    ds_read_b64_tr_b16 v[112:113], v152 offset:38912
    ds_read_b64_tr_b16 v[114:115], v152 offset:39424
    s_add_u32 s91, s91, 4096
    v_mfma_f32_32x32x16_bf16 v[96:111], v[124:127], a[20:23], v[96:111]
    ds_read_b64_tr_b16 v[116:117], v153 offset:38912
    ds_read_b64_tr_b16 v[118:119], v153 offset:39424
    buffer_load_dwordx4 a[112:115], v2, s[60:63], s91 offen offset:0 sc1
    s_waitcnt vmcnt(22)
    v_mfma_f32_32x32x16_bf16 v[16:31], v[128:131], a[24:27], v[16:31]
    ds_read_b64_tr_b16 v[120:121], v152 offset:7168
    ds_read_b64_tr_b16 v[122:123], v152 offset:7680
    buffer_load_dwordx4 a[116:119], v2, s[60:63], s91 offen offset:1024 sc1
    s_waitcnt lgkmcnt(6)
    v_mfma_f32_32x32x16_bf16 v[32:47], v[132:135], a[24:27], v[32:47]
    ds_read_b64_tr_b16 v[124:125], v153 offset:7168
    ds_read_b64_tr_b16 v[126:127], v153 offset:7680
    buffer_load_dwordx4 a[120:123], v2, s[60:63], s91 offen offset:2048 sc1
    v_mfma_f32_32x32x16_bf16 v[48:63], v[136:139], a[24:27], v[48:63]
    ds_read_b64_tr_b16 v[128:129], v152 offset:23552
    ds_read_b64_tr_b16 v[130:131], v152 offset:24064
    buffer_load_dwordx4 a[124:127], v2, s[60:63], s91 offen offset:3072 sc1
    v_mfma_f32_32x32x16_bf16 v[64:79], v[140:143], a[24:27], v[64:79]
    ds_read_b64_tr_b16 v[132:133], v153 offset:23552
    ds_read_b64_tr_b16 v[134:135], v153 offset:24064
    s_waitcnt lgkmcnt(6)
    v_mfma_f32_32x32x16_bf16 v[80:95], v[112:115], a[24:27], v[80:95]
    ds_read_b64_tr_b16 v[136:137], v152 offset:39936
    ds_read_b64_tr_b16 v[138:139], v152 offset:40448
    v_mfma_f32_32x32x16_bf16 v[96:111], v[116:119], a[24:27], v[96:111]
    ds_read_b64_tr_b16 v[140:141], v153 offset:39936
    ds_read_b64_tr_b16 v[142:143], v153 offset:40448
    s_waitcnt vmcnt(24)
    v_mfma_f32_32x32x16_bf16 v[16:31], v[120:123], a[28:31], v[16:31]
    ds_read_b64_tr_b16 v[112:113], v154 offset:0
    ds_read_b64_tr_b16 v[114:115], v154 offset:512
    s_waitcnt lgkmcnt(8)
    v_mfma_f32_32x32x16_bf16 v[32:47], v[124:127], a[28:31], v[32:47]
    ds_read_b64_tr_b16 v[116:117], v155 offset:0
    ds_read_b64_tr_b16 v[118:119], v155 offset:512
    v_mfma_f32_32x32x16_bf16 v[48:63], v[128:131], a[28:31], v[48:63]
    ds_read_b64_tr_b16 v[120:121], v154 offset:8192
    ds_read_b64_tr_b16 v[122:123], v154 offset:8704
    s_waitcnt lgkmcnt(8)
    v_mfma_f32_32x32x16_bf16 v[64:79], v[132:135], a[28:31], v[64:79]
    s_waitcnt lgkmcnt(6)
    s_barrier
    ds_read_b64_tr_b16 v[124:125], v155 offset:8192
    ds_read_b64_tr_b16 v[126:127], v155 offset:8704
    v_mfma_f32_32x32x16_bf16 v[80:95], v[136:139], a[28:31], v[80:95]
    ds_read_b64_tr_b16 v[128:129], v154 offset:16384
    ds_read_b64_tr_b16 v[130:131], v154 offset:16896
    s_lshl_b32 s4, s24, 2
    s_add_u32 s4, s4, s68
    v_mfma_f32_32x32x16_bf16 v[96:111], v[140:143], a[28:31], v[96:111]
    ds_read_b64_tr_b16 v[132:133], v155 offset:16384
    ds_read_b64_tr_b16 v[134:135], v155 offset:16896
    s_mul_i32 s4, s4, 88064
    s_waitcnt vmcnt(23) lgkmcnt(6)
    v_mfma_f32_32x32x16_bf16 v[16:31], v[112:115], a[32:35], v[16:31]
    ds_read_b64_tr_b16 v[136:137], v154 offset:1024
    ds_read_b64_tr_b16 v[138:139], v154 offset:1536
    s_add_u32 s4, s4, s12
    s_lshl_b32 s5, s68, 11
    v_mfma_f32_32x32x16_bf16 v[32:47], v[116:119], a[32:35], v[32:47]
    ds_read_b64_tr_b16 v[140:141], v155 offset:1024
    ds_read_b64_tr_b16 v[142:143], v155 offset:1536
    s_add_u32 m0, s5, 0
    v_mfma_f32_32x32x16_bf16 v[48:63], v[120:123], a[32:35], v[48:63]
    ds_read_b64_tr_b16 v[112:113], v154 offset:9216
    ds_read_b64_tr_b16 v[114:115], v154 offset:9728
    buffer_load_dwordx4 v6, s[40:43], s4 offen lds
    s_add_u32 m0, s5, 16320
    s_waitcnt lgkmcnt(5)
    v_mfma_f32_32x32x16_bf16 v[64:79], v[124:127], a[32:35], v[64:79]
    ds_read_b64_tr_b16 v[116:117], v155 offset:9216
    ds_read_b64_tr_b16 v[118:119], v155 offset:9728
    buffer_load_dwordx4 v6, s[40:43], s4 offen offset:64 lds
    v_mfma_f32_32x32x16_bf16 v[80:95], v[128:131], a[32:35], v[80:95]
    ds_read_b64_tr_b16 v[120:121], v154 offset:17408
    ds_read_b64_tr_b16 v[122:123], v154 offset:17920
    s_add_u32 m0, s5, 32640
    v_mfma_f32_32x32x16_bf16 v[96:111], v[132:135], a[32:35], v[96:111]
    ds_read_b64_tr_b16 v[124:125], v155 offset:17408
    ds_read_b64_tr_b16 v[126:127], v155 offset:17920
    buffer_load_dwordx4 v6, s[40:43], s4 offen offset:128 lds
    s_add_u32 m0, s5, 8192
    s_waitcnt vmcnt(25) lgkmcnt(6)
    v_mfma_f32_32x32x16_bf16 v[16:31], v[136:139], a[36:39], v[16:31]
    ds_read_b64_tr_b16 v[128:129], v154 offset:2048
    ds_read_b64_tr_b16 v[130:131], v154 offset:2560
    buffer_load_dwordx4 v13, s[44:47], s4 offen lds
    v_mfma_f32_32x32x16_bf16 v[32:47], v[140:143], a[36:39], v[32:47]
    ds_read_b64_tr_b16 v[132:133], v155 offset:2048
    ds_read_b64_tr_b16 v[134:135], v155 offset:2560
    s_add_u32 m0, s5, 24512
    v_mfma_f32_32x32x16_bf16 v[48:63], v[112:115], a[36:39], v[48:63]
    ds_read_b64_tr_b16 v[136:137], v154 offset:10240
    ds_read_b64_tr_b16 v[138:139], v154 offset:10752
    buffer_load_dwordx4 v13, s[44:47], s4 offen offset:64 lds
    s_waitcnt lgkmcnt(6)
    v_mfma_f32_32x32x16_bf16 v[64:79], v[116:119], a[36:39], v[64:79]
    ds_read_b64_tr_b16 v[140:141], v155 offset:10240
    ds_read_b64_tr_b16 v[142:143], v155 offset:10752
    s_add_u32 m0, s5, 40832
    v_mfma_f32_32x32x16_bf16 v[80:95], v[120:123], a[36:39], v[80:95]
    ds_read_b64_tr_b16 v[112:113], v154 offset:18432
    ds_read_b64_tr_b16 v[114:115], v154 offset:18944
    buffer_load_dwordx4 v13, s[44:47], s4 offen offset:128 lds
    s_add_u32 s4, s4, 44032
    v_mfma_f32_32x32x16_bf16 v[96:111], v[124:127], a[36:39], v[96:111]
    ds_read_b64_tr_b16 v[116:117], v155 offset:18432
    ds_read_b64_tr_b16 v[118:119], v155 offset:18944
    s_add_u32 m0, s5, 1024
    s_waitcnt vmcnt(27) lgkmcnt(6)
    v_mfma_f32_32x32x16_bf16 v[16:31], v[128:131], a[40:43], v[16:31]
    ds_read_b64_tr_b16 v[120:121], v154 offset:3072
    ds_read_b64_tr_b16 v[122:123], v154 offset:3584
    buffer_load_dwordx4 v6, s[40:43], s4 offen lds
    v_mfma_f32_32x32x16_bf16 v[32:47], v[132:135], a[40:43], v[32:47]
    ds_read_b64_tr_b16 v[124:125], v155 offset:3072
    ds_read_b64_tr_b16 v[126:127], v155 offset:3584
    s_add_u32 m0, s5, 17344
    v_mfma_f32_32x32x16_bf16 v[48:63], v[136:139], a[40:43], v[48:63]
    ds_read_b64_tr_b16 v[128:129], v154 offset:11264
    ds_read_b64_tr_b16 v[130:131], v154 offset:11776
    buffer_load_dwordx4 v6, s[40:43], s4 offen offset:64 lds
    s_add_u32 m0, s5, 33664
    s_waitcnt lgkmcnt(6)
    v_mfma_f32_32x32x16_bf16 v[64:79], v[140:143], a[40:43], v[64:79]
    ds_read_b64_tr_b16 v[132:133], v155 offset:11264
    ds_read_b64_tr_b16 v[134:135], v155 offset:11776
    buffer_load_dwordx4 v6, s[40:43], s4 offen offset:128 lds
    s_add_u32 m0, s5, 9216
    v_mfma_f32_32x32x16_bf16 v[80:95], v[112:115], a[40:43], v[80:95]
    ds_read_b64_tr_b16 v[136:137], v154 offset:19456
    ds_read_b64_tr_b16 v[138:139], v154 offset:19968
    buffer_load_dwordx4 v13, s[44:47], s4 offen lds
    v_mfma_f32_32x32x16_bf16 v[96:111], v[116:119], a[40:43], v[96:111]
    ds_read_b64_tr_b16 v[140:141], v155 offset:19456
    ds_read_b64_tr_b16 v[142:143], v155 offset:19968
    s_add_u32 m0, s5, 25536
    s_waitcnt vmcnt(30) lgkmcnt(6)
    v_mfma_f32_32x32x16_bf16 v[16:31], v[120:123], a[44:47], v[16:31]
    ds_read_b64_tr_b16 v[112:113], v154 offset:4096
    ds_read_b64_tr_b16 v[114:115], v154 offset:4608
    buffer_load_dwordx4 v13, s[44:47], s4 offen offset:64 lds
    s_add_u32 m0, s5, 41856
    v_mfma_f32_32x32x16_bf16 v[32:47], v[124:127], a[44:47], v[32:47]
    ds_read_b64_tr_b16 v[116:117], v155 offset:4096
    ds_read_b64_tr_b16 v[118:119], v155 offset:4608
    buffer_load_dwordx4 v13, s[44:47], s4 offen offset:128 lds
    v_min_u32 v5, 10, v1
    v_lshlrev_b32_e64 v5, 10, v5
    v_mfma_f32_32x32x16_bf16 v[48:63], v[128:131], a[44:47], v[48:63]
    ds_read_b64_tr_b16 v[120:121], v154 offset:12288
    ds_read_b64_tr_b16 v[122:123], v154 offset:12800
    s_mul_i32 s13, s7, 11264
    s_waitcnt lgkmcnt(4)
    v_mfma_f32_32x32x16_bf16 v[64:79], v[132:135], a[44:47], v[64:79]
    ds_read_b64_tr_b16 v[124:125], v155 offset:12288
    ds_read_b64_tr_b16 v[126:127], v155 offset:12800
    buffer_load_dword v14, v5, s[48:51], s13 offen offset:384
    v_mfma_f32_32x32x16_bf16 v[80:95], v[136:139], a[44:47], v[80:95]
    ds_read_b64_tr_b16 v[128:129], v154 offset:20480
    ds_read_b64_tr_b16 v[130:131], v154 offset:20992
    s_mov_b32 s4, s17
    v_mfma_f32_32x32x16_bf16 v[96:111], v[140:143], a[44:47], v[96:111]
    ds_read_b64_tr_b16 v[132:133], v155 offset:20480
    ds_read_b64_tr_b16 v[134:135], v155 offset:20992
    s_waitcnt vmcnt(32)
    v_mfma_f32_32x32x16_bf16 v[16:31], v[112:115], a[48:51], v[16:31]
    ds_read_b64_tr_b16 v[136:137], v154 offset:5120
    ds_read_b64_tr_b16 v[138:139], v154 offset:5632
    s_mov_b32 s5, s19
    s_waitcnt lgkmcnt(6)
    v_mfma_f32_32x32x16_bf16 v[32:47], v[116:119], a[48:51], v[32:47]
    ds_read_b64_tr_b16 v[140:141], v155 offset:5120
    ds_read_b64_tr_b16 v[142:143], v155 offset:5632
    v_mfma_f32_32x32x16_bf16 v[48:63], v[120:123], a[48:51], v[48:63]
    ds_read_b64_tr_b16 v[112:113], v154 offset:13312
    ds_read_b64_tr_b16 v[114:115], v154 offset:13824
    s_add_u32 m0, s5, 147456
    v_mfma_f32_32x32x16_bf16 v[64:79], v[124:127], a[48:51], v[64:79]
    ds_read_b64_tr_b16 v[116:117], v155 offset:13312
    ds_read_b64_tr_b16 v[118:119], v155 offset:13824
    s_waitcnt lgkmcnt(7)
    v_mfma_f32_32x32x16_bf16 v[80:95], v[128:131], a[48:51], v[80:95]
    ds_read_b64_tr_b16 v[120:121], v154 offset:21504
    ds_read_b64_tr_b16 v[122:123], v154 offset:22016
    s_add_u32 s6, s4, 557056
    v_mfma_f32_32x32x16_bf16 v[96:111], v[132:135], a[48:51], v[96:111]
    ds_read_b64_tr_b16 v[124:125], v155 offset:21504
    ds_read_b64_tr_b16 v[126:127], v155 offset:22016
    s_waitcnt vmcnt(31) lgkmcnt(7)
    v_mfma_f32_32x32x16_bf16 v[16:31], v[136:139], a[52:55], v[16:31]
    ds_read_b64_tr_b16 v[128:129], v154 offset:6144
    ds_read_b64_tr_b16 v[130:131], v154 offset:6656
    buffer_load_dwordx4 v166, s[48:51], s6 offen lds
    v_mfma_f32_32x32x16_bf16 v[32:47], v[140:143], a[52:55], v[32:47]
    ds_read_b64_tr_b16 v[132:133], v155 offset:6144
    ds_read_b64_tr_b16 v[134:135], v155 offset:6656
    s_waitcnt lgkmcnt(7)
    v_mfma_f32_32x32x16_bf16 v[48:63], v[112:115], a[52:55], v[48:63]
    ds_read_b64_tr_b16 v[136:137], v154 offset:14336
    ds_read_b64_tr_b16 v[138:139], v154 offset:14848
    s_add_u32 m0, s5, 149504
    v_mfma_f32_32x32x16_bf16 v[64:79], v[116:119], a[52:55], v[64:79]
    ds_read_b64_tr_b16 v[140:141], v155 offset:14336
    ds_read_b64_tr_b16 v[142:143], v155 offset:14848
    s_waitcnt lgkmcnt(7)
    v_mfma_f32_32x32x16_bf16 v[80:95], v[120:123], a[52:55], v[80:95]
    ds_read_b64_tr_b16 v[112:113], v154 offset:22528
    ds_read_b64_tr_b16 v[114:115], v154 offset:23040
    s_add_u32 s6, s4, 655360
    v_mfma_f32_32x32x16_bf16 v[96:111], v[124:127], a[52:55], v[96:111]
    ds_read_b64_tr_b16 v[116:117], v155 offset:22528
    ds_read_b64_tr_b16 v[118:119], v155 offset:23040
    s_waitcnt vmcnt(31) lgkmcnt(7)
    v_mfma_f32_32x32x16_bf16 v[16:31], v[128:131], a[56:59], v[16:31]
    ds_read_b64_tr_b16 v[120:121], v154 offset:7168
    ds_read_b64_tr_b16 v[122:123], v154 offset:7680
    v_mfma_f32_32x32x16_bf16 v[32:47], v[132:135], a[56:59], v[32:47]
    ds_read_b64_tr_b16 v[124:125], v155 offset:7168
    ds_read_b64_tr_b16 v[126:127], v155 offset:7680
    buffer_load_dwordx4 v4, s[48:51], s6 offen lds
    s_waitcnt lgkmcnt(7)
    v_mfma_f32_32x32x16_bf16 v[48:63], v[136:139], a[56:59], v[48:63]
    ds_read_b64_tr_b16 v[128:129], v154 offset:15360
    ds_read_b64_tr_b16 v[130:131], v154 offset:15872
    v_mfma_f32_32x32x16_bf16 v[64:79], v[140:143], a[56:59], v[64:79]
    ds_read_b64_tr_b16 v[132:133], v155 offset:15360
    ds_read_b64_tr_b16 v[134:135], v155 offset:15872
    s_add_u32 m0, s5, 151552
    s_waitcnt lgkmcnt(7)
    v_mfma_f32_32x32x16_bf16 v[80:95], v[112:115], a[56:59], v[80:95]
    ds_read_b64_tr_b16 v[136:137], v154 offset:23552
    ds_read_b64_tr_b16 v[138:139], v154 offset:24064
    v_mfma_f32_32x32x16_bf16 v[96:111], v[116:119], a[56:59], v[96:111]
    ds_read_b64_tr_b16 v[140:141], v155 offset:23552
    ds_read_b64_tr_b16 v[142:143], v155 offset:24064
    buffer_load_dwordx4 v166, s[48:51], s6 offen lds
    s_waitcnt vmcnt(32) lgkmcnt(7)
    v_mfma_f32_32x32x16_bf16 v[16:31], v[120:123], a[60:63], v[16:31]
    ds_read_b64_tr_b16 v[112:113], v156 offset:0
    ds_read_b64_tr_b16 v[114:115], v156 offset:512
    v_mfma_f32_32x32x16_bf16 v[32:47], v[124:127], a[60:63], v[32:47]
    ds_read_b64_tr_b16 v[116:117], v156 offset:1024
    ds_read_b64_tr_b16 v[118:119], v156 offset:1536
    s_add_u32 m0, s5, 153600
    s_waitcnt lgkmcnt(7)
    v_mfma_f32_32x32x16_bf16 v[48:63], v[128:131], a[60:63], v[48:63]
    ds_read_b64_tr_b16 v[120:121], v156 offset:2048
    ds_read_b64_tr_b16 v[122:123], v156 offset:2560
    v_mfma_f32_32x32x16_bf16 v[64:79], v[132:135], a[60:63], v[64:79]
    ds_read_b64_tr_b16 v[124:125], v156 offset:3072
    ds_read_b64_tr_b16 v[126:127], v156 offset:3584
    s_add_u32 s6, s4, 524288
    s_waitcnt lgkmcnt(7)
    v_mfma_f32_32x32x16_bf16 v[80:95], v[136:139], a[60:63], v[80:95]
    ds_read_b64_tr_b16 v[128:129], v156 offset:4096
    ds_read_b64_tr_b16 v[130:131], v156 offset:4608
    v_mfma_f32_32x32x16_bf16 v[96:111], v[140:143], a[60:63], v[96:111]
    ds_read_b64_tr_b16 v[132:133], v156 offset:5120
    ds_read_b64_tr_b16 v[134:135], v156 offset:5632
    buffer_load_dwordx4 v4, s[48:51], s6 offen lds
    s_waitcnt vmcnt(32) lgkmcnt(7)
    v_mfma_f32_32x32x16_bf16 v[16:31], v[112:115], a[64:67], v[16:31]
    ds_read_b64_tr_b16 v[136:137], v156 offset:6144
    ds_read_b64_tr_b16 v[138:139], v156 offset:6656
    s_waitcnt vmcnt(31)
    v_mfma_f32_32x32x16_bf16 v[16:31], v[116:119], a[68:71], v[16:31]
    s_waitcnt vmcnt(5)
    s_barrier
    ds_read_b64_tr_b16 v[140:141], v156 offset:7168
    ds_read_b64_tr_b16 v[142:143], v156 offset:7680
    s_waitcnt lgkmcnt(8)
    v_mfma_f32_32x32x16_bf16 v[16:31], v[120:123], a[72:75], v[16:31]
    ds_read_b64_tr_b16 v[112:113], v152 offset:0
    ds_read_b64_tr_b16 v[114:115], v152 offset:512
    v_mov_b32 v7, s75
    s_mov_b64 exec, 1
    s_cmp_eq_u32 s76, 0
    s_cbranch_scc1 L_slow_29
    buffer_store_dword v7, off, s[64:67], s8 offset:1280
L_join_30:
    s_mov_b64 exec, -1
    v_mfma_f32_32x32x16_bf16 v[16:31], v[124:127], a[76:79], v[16:31]
    ds_read_b64_tr_b16 v[116:117], v152 offset:1024
    ds_read_b64_tr_b16 v[118:119], v152 offset:1536
    s_mov_b32 s4, s17
    s_mov_b32 s5, s18
    s_add_u32 m0, s5, 49152
    s_mul_i32 s6, s78, 4294295552
    s_waitcnt lgkmcnt(2)
    v_mfma_f32_32x32x16_bf16 v[16:31], v[128:131], a[80:83], v[16:31]
    ds_read_b64_tr_b16 v[120:121], v152 offset:2048
    ds_read_b64_tr_b16 v[122:123], v152 offset:2560
    s_add_u32 s6, s6, s4
    s_add_u32 s6, s6, 1376256
    v_mfma_f32_32x32x16_bf16 v[16:31], v[132:135], a[84:87], v[16:31]
    ds_read_b64_tr_b16 v[124:125], v152 offset:3072
    ds_read_b64_tr_b16 v[126:127], v152 offset:3584
    buffer_load_dwordx4 v4, s[48:51], s6 offen lds
    s_add_u32 m0, s5, 51200
    v_mfma_f32_32x32x16_bf16 v[16:31], v[136:139], a[88:91], v[16:31]
    ds_read_b64_tr_b16 v[128:129], v152 offset:4096
    ds_read_b64_tr_b16 v[130:131], v152 offset:4608
    s_add_u32 s6, s4, 0
    v_mfma_f32_32x32x16_bf16 v[16:31], v[140:143], a[92:95], v[16:31]
    ds_read_b64_tr_b16 v[132:133], v152 offset:5120
    ds_read_b64_tr_b16 v[134:135], v152 offset:5632
    buffer_load_dwordx4 v4, s[48:51], s6 offen lds
    s_add_u32 m0, s5, 53248
    v_mfma_f32_32x32x16_bf16 v[16:31], v[112:115], a[96:99], v[16:31]
    ds_read_b64_tr_b16 v[136:137], v152 offset:6144
    ds_read_b64_tr_b16 v[138:139], v152 offset:6656
    buffer_load_dwordx4 v166, s[48:51], s6 offen lds
    s_waitcnt lgkmcnt(6)
    v_mfma_f32_32x32x16_bf16 v[16:31], v[116:119], a[100:103], v[16:31]
    ds_read_b64_tr_b16 v[140:141], v152 offset:7168
    ds_read_b64_tr_b16 v[142:143], v152 offset:7680
    s_add_u32 m0, s5, 55296
    s_add_u32 s6, s4, 98304
    v_mfma_f32_32x32x16_bf16 v[16:31], v[120:123], a[104:107], v[16:31]
    ds_read_b64_tr_b16 v[112:113], v157 offset:0
    ds_read_b64_tr_b16 v[114:115], v157 offset:512
    buffer_load_dwordx4 v4, s[48:51], s6 offen lds
    s_add_u32 m0, s5, 57344
    v_mfma_f32_32x32x16_bf16 v[16:31], v[124:127], a[108:111], v[16:31]
    ds_read_b64_tr_b16 v[116:117], v157 offset:1024
    ds_read_b64_tr_b16 v[118:119], v157 offset:1536
    buffer_load_dwordx4 v166, s[48:51], s6 offen lds
    s_add_u32 m0, s5, 59392
    s_waitcnt lgkmcnt(4)
    v_mfma_f32_32x32x16_bf16 v[16:31], v[128:131], a[112:115], v[16:31]
    ds_read_b64_tr_b16 v[120:121], v157 offset:2048
    ds_read_b64_tr_b16 v[122:123], v157 offset:2560
    s_add_u32 s6, s4, 196608
    v_mfma_f32_32x32x16_bf16 v[16:31], v[132:135], a[116:119], v[16:31]
    ds_read_b64_tr_b16 v[124:125], v157 offset:3072
    ds_read_b64_tr_b16 v[126:127], v157 offset:3584
    buffer_load_dwordx4 v4, s[48:51], s6 offen lds
    s_add_u32 m0, s5, 61440
    v_mfma_f32_32x32x16_bf16 v[16:31], v[136:139], a[120:123], v[16:31]
    ds_read_b64_tr_b16 v[128:129], v157 offset:4096
    ds_read_b64_tr_b16 v[130:131], v157 offset:4608
    buffer_load_dwordx4 v166, s[48:51], s6 offen lds
    s_add_u32 m0, s5, 63488
    v_mfma_f32_32x32x16_bf16 v[16:31], v[140:143], a[124:127], v[16:31]
    ds_read_b64_tr_b16 v[132:133], v157 offset:5120
    ds_read_b64_tr_b16 v[134:135], v157 offset:5632
    s_add_u32 s6, s4, 294912
    s_waitcnt lgkmcnt(5)
    v_mfma_f32_32x32x16_bf16 v[32:47], v[112:115], a[64:67], v[32:47]
    ds_read_b64_tr_b16 v[136:137], v157 offset:6144
    ds_read_b64_tr_b16 v[138:139], v157 offset:6656
    buffer_load_dwordx4 v4, s[48:51], s6 offen lds
    v_mfma_f32_32x32x16_bf16 v[32:47], v[116:119], a[68:71], v[32:47]
    ds_read_b64_tr_b16 v[140:141], v157 offset:7168
    ds_read_b64_tr_b16 v[142:143], v157 offset:7680
    s_add_u32 m0, s5, 65536
    v_mfma_f32_32x32x16_bf16 v[32:47], v[120:123], a[72:75], v[32:47]
    ds_read_b64_tr_b16 v[112:113], v153 offset:0
    ds_read_b64_tr_b16 v[114:115], v153 offset:512
    buffer_load_dwordx4 v166, s[48:51], s6 offen lds
    s_add_u32 m0, s5, 67584
    s_waitcnt lgkmcnt(6)
    v_mfma_f32_32x32x16_bf16 v[32:47], v[124:127], a[76:79], v[32:47]
    ds_read_b64_tr_b16 v[116:117], v153 offset:1024
    ds_read_b64_tr_b16 v[118:119], v153 offset:1536
    v_exp_f32 v16, v16
    v_exp_f32 v17, v17
    v_exp_f32_e64 v18, v18
    s_add_u32 s6, s4, 393216
    v_mfma_f32_32x32x16_bf16 v[32:47], v[128:131], a[80:83], v[32:47]
    ds_read_b64_tr_b16 v[120:121], v153 offset:2048
    ds_read_b64_tr_b16 v[122:123], v153 offset:2560
    buffer_load_dwordx4 v4, s[48:51], s6 offen lds
    v_exp_f32_e64 v19, v19
    v_mfma_f32_32x32x16_bf16 v[32:47], v[132:135], a[84:87], v[32:47]
    ds_read_b64_tr_b16 v[124:125], v153 offset:3072
    ds_read_b64_tr_b16 v[126:127], v153 offset:3584
    v_exp_f32 v20, v20
    v_exp_f32 v21, v21
    v_exp_f32_e64 v22, v22
    s_add_u32 m0, s5, 69632
    s_waitcnt lgkmcnt(4)
    v_mfma_f32_32x32x16_bf16 v[32:47], v[136:139], a[88:91], v[32:47]
    ds_read_b64_tr_b16 v[128:129], v153 offset:4096
    ds_read_b64_tr_b16 v[130:131], v153 offset:4608
    buffer_load_dwordx4 v166, s[48:51], s6 offen lds
    v_exp_f32 v23, v23
    v_add_f32_e64 v16, 1.0, v16
    s_add_u32 m0, s5, 71680
    v_mfma_f32_32x32x16_bf16 v[32:47], v[140:143], a[92:95], v[32:47]
    ds_read_b64_tr_b16 v[132:133], v153 offset:5120
    ds_read_b64_tr_b16 v[134:135], v153 offset:5632
    v_add_f32 v17, 1.0, v17
    v_add_f32 v18, 1.0, v18
    v_add_f32 v19, 1.0, v19
    v_add_f32 v20, 1.0, v20
    v_add_f32 v21, 1.0, v21
    v_add_f32 v22, 1.0, v22
    s_add_u32 s6, s4, 491520
    v_mfma_f32_32x32x16_bf16 v[32:47], v[112:115], a[96:99], v[32:47]
    ds_read_b64_tr_b16 v[136:137], v153 offset:6144
    ds_read_b64_tr_b16 v[138:139], v153 offset:6656
    buffer_load_dwordx4 v4, s[48:51], s6 offen lds
    v_add_f32 v23, 1.0, v23
    v_rcp_f32 v16, v16
    v_mfma_f32_32x32x16_bf16 v[32:47], v[116:119], a[100:103], v[32:47]
    ds_read_b64_tr_b16 v[140:141], v153 offset:7168
    ds_read_b64_tr_b16 v[142:143], v153 offset:7680
    v_rcp_f32 v17, v17
    v_rcp_f32 v18, v18
    v_rcp_f32 v19, v19
    s_waitcnt lgkmcnt(4)
    v_mfma_f32_32x32x16_bf16 v[32:47], v[120:123], a[104:107], v[32:47]
    ds_read_b64_tr_b16 v[112:113], v156 offset:16384
    ds_read_b64_tr_b16 v[114:115], v156 offset:16896
    v_rcp_f32 v20, v20
    v_rcp_f32 v21, v21
    v_rcp_f32_e64 v22, v22
    v_mfma_f32_32x32x16_bf16 v[32:47], v[124:127], a[108:111], v[32:47]
    ds_read_b64_tr_b16 v[116:117], v156 offset:17408
    ds_read_b64_tr_b16 v[118:119], v156 offset:17920
    v_rcp_f32 v23, v23
    v_mul_f32 v16, v16, v24
    v_mul_f32 v17, v17, v25
    v_mul_f32 v18, v18, v26
    v_mul_f32 v19, v19, v27
    v_mul_f32 v20, v20, v28
    v_mfma_f32_32x32x16_bf16 v[32:47], v[128:131], a[112:115], v[32:47]
    ds_read_b64_tr_b16 v[120:121], v156 offset:18432
    ds_read_b64_tr_b16 v[122:123], v156 offset:18944
    buffer_load_dword v158, v3, s[64:67], s74 offen offset:1280 sc1
    v_mul_f32 v21, v21, v29
    v_mul_f32 v22, v22, v30
    v_mul_f32_e64 v23, v23, v31
    v_mfma_f32_32x32x16_bf16 v[32:47], v[132:135], a[116:119], v[32:47]
    s_waitcnt lgkmcnt(6)
    s_barrier
    ds_read_b64_tr_b16 v[124:125], v156 offset:19456
    ds_read_b64_tr_b16 v[126:127], v156 offset:19968
    v_cvt_pk_bf16_f32 v144, v16, v17
    v_cvt_pk_bf16_f32 v145, v18, v19
    v_cvt_pk_bf16_f32 v146, v20, v21
    v_cvt_pk_bf16_f32 v147, v22, v23
    v_mfma_f32_32x32x16_bf16 v[32:47], v[136:139], a[120:123], v[32:47]
    ds_read_b64_tr_b16 v[128:129], v156 offset:20480
    ds_read_b64_tr_b16 v[130:131], v156 offset:20992
    buffer_store_dwordx4 v[144:147], v2, s[64:67], s14 offen offset:0 sc1
    s_mov_b32 s4, s17
    s_mov_b32 s5, s20
    s_add_u32 m0, s5, 98304
    v_mfma_f32_32x32x16_bf16 v[32:47], v[140:143], a[124:127], v[32:47]
    ds_read_b64_tr_b16 v[132:133], v156 offset:21504
    ds_read_b64_tr_b16 v[134:135], v156 offset:22016
    s_add_u32 s6, s4, 491520
    s_waitcnt lgkmcnt(4)
    v_mfma_f32_32x32x16_bf16 v[48:63], v[112:115], a[64:67], v[48:63]
    ds_read_b64_tr_b16 v[136:137], v156 offset:22528
    ds_read_b64_tr_b16 v[138:139], v156 offset:23040
    v_mfma_f32_32x32x16_bf16 v[48:63], v[116:119], a[68:71], v[48:63]
    ds_read_b64_tr_b16 v[140:141], v156 offset:23552
    ds_read_b64_tr_b16 v[142:143], v156 offset:24064
    buffer_load_dwordx4 v166, s[48:51], s6 offen lds
    v_mfma_f32_32x32x16_bf16 v[48:63], v[120:123], a[72:75], v[48:63]
    ds_read_b64_tr_b16 v[112:113], v152 offset:16384
    ds_read_b64_tr_b16 v[114:115], v152 offset:16896
    s_add_u32 m0, s5, 100352
    s_add_u32 s6, s4, 589824
    v_mfma_f32_32x32x16_bf16 v[48:63], v[124:127], a[76:79], v[48:63]
    ds_read_b64_tr_b16 v[116:117], v152 offset:17408
    ds_read_b64_tr_b16 v[118:119], v152 offset:17920
    buffer_load_dwordx4 v4, s[48:51], s6 offen lds
    v_exp_f32 v32, v32
    v_exp_f32 v33, v33
    s_waitcnt lgkmcnt(4)
    v_mfma_f32_32x32x16_bf16 v[48:63], v[128:131], a[80:83], v[48:63]
    ds_read_b64_tr_b16 v[120:121], v152 offset:18432
    ds_read_b64_tr_b16 v[122:123], v152 offset:18944
    v_exp_f32 v34, v34
    v_exp_f32 v35, v35
    s_add_u32 m0, s5, 102400
    v_mfma_f32_32x32x16_bf16 v[48:63], v[132:135], a[84:87], v[48:63]
    ds_read_b64_tr_b16 v[124:125], v152 offset:19456
    ds_read_b64_tr_b16 v[126:127], v152 offset:19968
    buffer_load_dwordx4 v166, s[48:51], s6 offen lds
    v_exp_f32 v36, v36
    v_exp_f32 v37, v37
    v_mfma_f32_32x32x16_bf16 v[48:63], v[136:139], a[88:91], v[48:63]
    ds_read_b64_tr_b16 v[128:129], v152 offset:20480
    ds_read_b64_tr_b16 v[130:131], v152 offset:20992
    v_exp_f32 v38, v38
    v_exp_f32 v39, v39
    v_add_f32_e64 v32, 1.0, v32
    s_add_u32 m0, s5, 104448
    s_add_u32 s6, s4, 32768
    v_mfma_f32_32x32x16_bf16 v[48:63], v[140:143], a[92:95], v[48:63]
    ds_read_b64_tr_b16 v[132:133], v152 offset:21504
    ds_read_b64_tr_b16 v[134:135], v152 offset:22016
    buffer_load_dwordx4 v4, s[48:51], s6 offen lds
    v_add_f32 v33, 1.0, v33
    v_add_f32 v34, 1.0, v34
    v_add_f32 v35, 1.0, v35
    v_add_f32 v36, 1.0, v36
    s_waitcnt lgkmcnt(2)
    v_mfma_f32_32x32x16_bf16 v[48:63], v[112:115], a[96:99], v[48:63]
    ds_read_b64_tr_b16 v[136:137], v152 offset:22528
    ds_read_b64_tr_b16 v[138:139], v152 offset:23040
    v_add_f32 v37, 1.0, v37
    v_add_f32 v38, 1.0, v38
    v_add_f32 v39, 1.0, v39
    v_rcp_f32_e64 v32, v32
    s_add_u32 m0, s5, 106496
    v_mfma_f32_32x32x16_bf16 v[48:63], v[116:119], a[100:103], v[48:63]
    ds_read_b64_tr_b16 v[140:141], v152 offset:23552
    ds_read_b64_tr_b16 v[142:143], v152 offset:24064
    buffer_load_dwordx4 v166, s[48:51], s6 offen lds
    v_rcp_f32 v33, v33
    v_rcp_f32 v34, v34
    v_mfma_f32_32x32x16_bf16 v[48:63], v[120:123], a[104:107], v[48:63]
    ds_read_b64_tr_b16 v[112:113], v157 offset:16384
    ds_read_b64_tr_b16 v[114:115], v157 offset:16896
    v_rcp_f32 v35, v35
    v_rcp_f32 v36, v36
    s_add_u32 m0, s5, 108544
    s_add_u32 s6, s4, 131072
    v_mfma_f32_32x32x16_bf16 v[48:63], v[124:127], a[108:111], v[48:63]
    ds_read_b64_tr_b16 v[116:117], v157 offset:17408
    ds_read_b64_tr_b16 v[118:119], v157 offset:17920
    buffer_load_dwordx4 v4, s[48:51], s6 offen lds
    v_rcp_f32 v37, v37
    v_rcp_f32 v38, v38
    v_mfma_f32_32x32x16_bf16 v[48:63], v[128:131], a[112:115], v[48:63]
    ds_read_b64_tr_b16 v[120:121], v157 offset:18432
    ds_read_b64_tr_b16 v[122:123], v157 offset:18944
    v_rcp_f32 v39, v39
    v_mul_f32 v32, v32, v40
    v_mul_f32 v33, v33, v41
    v_mul_f32 v34, v34, v42
    s_add_u32 m0, s5, 110592
    s_waitcnt lgkmcnt(3)
    v_mfma_f32_32x32x16_bf16 v[48:63], v[132:135], a[116:119], v[48:63]
    ds_read_b64_tr_b16 v[124:125], v157 offset:19456
    ds_read_b64_tr_b16 v[126:127], v157 offset:19968
    buffer_load_dwordx4 v166, s[48:51], s6 offen lds
    v_mul_f32 v35, v35, v43
    v_mul_f32 v36, v36, v44
    v_mul_f32 v37, v37, v45
    v_mul_f32_e64 v38, v38, v46
    v_mfma_f32_32x32x16_bf16 v[48:63], v[136:139], a[120:123], v[48:63]
    ds_read_b64_tr_b16 v[128:129], v157 offset:20480
    ds_read_b64_tr_b16 v[130:131], v157 offset:20992
    v_mul_f32_e64 v39, v39, v47
    v_cvt_pk_bf16_f32 v148, v32, v33
    v_cvt_pk_bf16_f32 v149, v34, v35
    v_cvt_pk_bf16_f32 v150, v36, v37
    v_cvt_pk_bf16_f32 v151, v38, v39
    s_add_u32 m0, s5, 112640
    s_add_u32 s6, s4, 229376
    v_mfma_f32_32x32x16_bf16 v[48:63], v[140:143], a[124:127], v[48:63]
    ds_read_b64_tr_b16 v[132:133], v157 offset:21504
    ds_read_b64_tr_b16 v[134:135], v157 offset:22016
    buffer_load_dwordx4 v4, s[48:51], s6 offen lds
    v_mfma_f32_32x32x16_bf16 v[64:79], v[112:115], a[64:67], v[64:79]
    ds_read_b64_tr_b16 v[136:137], v157 offset:22528
    ds_read_b64_tr_b16 v[138:139], v157 offset:23040
    buffer_store_dwordx4 v[148:151], v2, s[64:67], s14 offen offset:1024 sc1
    s_add_u32 s6, s17, 163840
    s_waitcnt lgkmcnt(4)
    v_mfma_f32_32x32x16_bf16 v[64:79], v[116:119], a[68:71], v[64:79]
    ds_read_b64_tr_b16 v[140:141], v157 offset:23552
    ds_read_b64_tr_b16 v[142:143], v157 offset:24064
    buffer_load_dwordx4 a[128:131], v166, s[48:51], s6 offen
    v_mfma_f32_32x32x16_bf16 v[64:79], v[120:123], a[72:75], v[64:79]
    ds_read_b64_tr_b16 v[112:113], v153 offset:16384
    ds_read_b64_tr_b16 v[114:115], v153 offset:16896
    s_add_u32 s6, s17, 262144
    v_mfma_f32_32x32x16_bf16 v[64:79], v[124:127], a[76:79], v[64:79]
    ds_read_b64_tr_b16 v[116:117], v153 offset:17408
    ds_read_b64_tr_b16 v[118:119], v153 offset:17920
    buffer_load_dwordx4 a[132:135], v4, s[48:51], s6 offen
    v_exp_f32 v48, v48
    v_exp_f32_e64 v49, v49
    v_mfma_f32_32x32x16_bf16 v[64:79], v[128:131], a[80:83], v[64:79]
    ds_read_b64_tr_b16 v[120:121], v153 offset:18432
    ds_read_b64_tr_b16 v[122:123], v153 offset:18944
    v_exp_f32 v50, v50
    v_exp_f32 v51, v51
    v_exp_f32 v52, v52
    s_waitcnt lgkmcnt(4)
    v_mfma_f32_32x32x16_bf16 v[64:79], v[132:135], a[84:87], v[64:79]
    ds_read_b64_tr_b16 v[124:125], v153 offset:19456
    ds_read_b64_tr_b16 v[126:127], v153 offset:19968
    buffer_load_dwordx4 a[136:139], v166, s[48:51], s6 offen
    v_exp_f32 v53, v53
    v_exp_f32 v54, v54
    v_mfma_f32_32x32x16_bf16 v[64:79], v[136:139], a[88:91], v[64:79]
    ds_read_b64_tr_b16 v[128:129], v153 offset:20480
    ds_read_b64_tr_b16 v[130:131], v153 offset:20992
    v_exp_f32 v55, v55
    v_add_f32 v48, 1.0, v48
    v_add_f32 v49, 1.0, v49
    v_add_f32 v50, 1.0, v50
    v_add_f32_e64 v51, 1.0, v51
    s_add_u32 s6, s17, 360448
    v_mfma_f32_32x32x16_bf16 v[64:79], v[140:143], a[92:95], v[64:79]
    ds_read_b64_tr_b16 v[132:133], v153 offset:21504
    ds_read_b64_tr_b16 v[134:135], v153 offset:22016
    buffer_load_dwordx4 a[140:143], v4, s[48:51], s6 offen
    v_add_f32 v52, 1.0, v52
    v_add_f32 v53, 1.0, v53
    v_add_f32 v54, 1.0, v54
    v_add_f32 v55, 1.0, v55
    v_mfma_f32_32x32x16_bf16 v[64:79], v[112:115], a[96:99], v[64:79]
    ds_read_b64_tr_b16 v[136:137], v153 offset:22528
    ds_read_b64_tr_b16 v[138:139], v153 offset:23040
    v_rcp_f32 v48, v48
    v_rcp_f32 v49, v49
    v_rcp_f32 v50, v50
    s_waitcnt lgkmcnt(3)
    v_mfma_f32_32x32x16_bf16 v[64:79], v[116:119], a[100:103], v[64:79]
    ds_read_b64_tr_b16 v[140:141], v153 offset:23552
    ds_read_b64_tr_b16 v[142:143], v153 offset:24064
    buffer_load_dwordx4 a[144:147], v166, s[48:51], s6 offen
    v_rcp_f32 v51, v51
    v_rcp_f32 v52, v52
    v_mfma_f32_32x32x16_bf16 v[64:79], v[120:123], a[104:107], v[64:79]
    ds_read_b64_tr_b16 v[112:113], v156 offset:32768
    ds_read_b64_tr_b16 v[114:115], v156 offset:33280
    v_rcp_f32 v53, v53
    v_rcp_f32 v54, v54
    v_rcp_f32_e64 v55, v55
    s_add_u32 s6, s17, 458752
    v_mfma_f32_32x32x16_bf16 v[64:79], v[124:127], a[108:111], v[64:79]
    ds_read_b64_tr_b16 v[116:117], v156 offset:33792
    ds_read_b64_tr_b16 v[118:119], v156 offset:34304
    buffer_load_dwordx4 a[148:151], v4, s[48:51], s6 offen
    v_mul_f32 v48, v48, v56
    v_mul_f32 v49, v49, v57
    v_mul_f32 v50, v50, v58
    v_mul_f32 v51, v51, v59
    v_mfma_f32_32x32x16_bf16 v[64:79], v[128:131], a[112:115], v[64:79]
    ds_read_b64_tr_b16 v[120:121], v156 offset:34816
    ds_read_b64_tr_b16 v[122:123], v156 offset:35328
    v_mul_f32 v52, v52, v60
    v_mul_f32 v53, v53, v61
    v_mul_f32 v54, v54, v62
    v_mul_f32 v55, v55, v63
    v_cvt_pk_bf16_f32 v144, v48, v49
    v_cvt_pk_bf16_f32 v145, v50, v51
    s_waitcnt lgkmcnt(2)
    v_mfma_f32_32x32x16_bf16 v[64:79], v[132:135], a[116:119], v[64:79]
    s_waitcnt vmcnt(17)
    s_barrier
    ds_read_b64_tr_b16 v[124:125], v156 offset:35840
    ds_read_b64_tr_b16 v[126:127], v156 offset:36352
    v_cvt_pk_bf16_f32 v146, v52, v53
    v_cvt_pk_bf16_f32 v147, v54, v55
    v_mfma_f32_32x32x16_bf16 v[64:79], v[136:139], a[120:123], v[64:79]
    ds_read_b64_tr_b16 v[128:129], v156 offset:36864
    ds_read_b64_tr_b16 v[130:131], v156 offset:37376
    buffer_store_dwordx4 v[144:147], v2, s[64:67], s15 offen offset:0 sc1
    s_mov_b32 s4, s17
    s_mov_b32 s5, s20
    v_mfma_f32_32x32x16_bf16 v[64:79], v[140:143], a[124:127], v[64:79]
    ds_read_b64_tr_b16 v[132:133], v156 offset:37888
    ds_read_b64_tr_b16 v[134:135], v156 offset:38400
    s_add_u32 m0, s5, 114688
    v_mfma_f32_32x32x16_bf16 v[80:95], v[112:115], a[64:67], v[80:95]
    ds_read_b64_tr_b16 v[136:137], v156 offset:38912
    ds_read_b64_tr_b16 v[138:139], v156 offset:39424
    s_add_u32 s6, s4, 229376
    v_mfma_f32_32x32x16_bf16 v[80:95], v[116:119], a[68:71], v[80:95]
    ds_read_b64_tr_b16 v[140:141], v156 offset:39936
    ds_read_b64_tr_b16 v[142:143], v156 offset:40448
    buffer_load_dwordx4 v166, s[48:51], s6 offen lds
    s_waitcnt lgkmcnt(6)
    v_mfma_f32_32x32x16_bf16 v[80:95], v[120:123], a[72:75], v[80:95]
    ds_read_b64_tr_b16 v[112:113], v152 offset:32768
    ds_read_b64_tr_b16 v[114:115], v152 offset:33280
    s_add_u32 m0, s5, 116736
    v_mfma_f32_32x32x16_bf16 v[80:95], v[124:127], a[76:79], v[80:95]
    ds_read_b64_tr_b16 v[116:117], v152 offset:33792
    ds_read_b64_tr_b16 v[118:119], v152 offset:34304
    v_exp_f32 v64, v64
    v_exp_f32 v65, v65
    v_exp_f32_e64 v66, v66
    s_add_u32 s6, s4, 327680
    v_mfma_f32_32x32x16_bf16 v[80:95], v[128:131], a[80:83], v[80:95]
    ds_read_b64_tr_b16 v[120:121], v152 offset:34816
    ds_read_b64_tr_b16 v[122:123], v152 offset:35328
    buffer_load_dwordx4 v4, s[48:51], s6 offen lds
    v_exp_f32 v67, v67
    s_waitcnt lgkmcnt(4)
    v_mfma_f32_32x32x16_bf16 v[80:95], v[132:135], a[84:87], v[80:95]
    ds_read_b64_tr_b16 v[124:125], v152 offset:35840
    ds_read_b64_tr_b16 v[126:127], v152 offset:36352
    v_exp_f32 v68, v68
    v_exp_f32 v69, v69
    v_exp_f32_e64 v70, v70
    s_add_u32 m0, s5, 118784
    v_mfma_f32_32x32x16_bf16 v[80:95], v[136:139], a[88:91], v[80:95]
    ds_read_b64_tr_b16 v[128:129], v152 offset:36864
    ds_read_b64_tr_b16 v[130:131], v152 offset:37376
    buffer_load_dwordx4 v166, s[48:51], s6 offen lds
    v_exp_f32 v71, v71
    v_add_f32 v64, 1.0, v64
    s_add_u32 m0, s5, 120832
    v_mfma_f32_32x32x16_bf16 v[80:95], v[140:143], a[92:95], v[80:95]
    ds_read_b64_tr_b16 v[132:133], v152 offset:37888
    ds_read_b64_tr_b16 v[134:135], v152 offset:38400
    v_add_f32 v65, 1.0, v65
    v_add_f32 v66, 1.0, v66
    v_add_f32 v67, 1.0, v67
    v_add_f32 v68, 1.0, v68
    v_add_f32 v69, 1.0, v69
    v_add_f32 v70, 1.0, v70
    s_add_u32 s6, s4, 425984
    v_mfma_f32_32x32x16_bf16 v[80:95], v[112:115], a[96:99], v[80:95]
    ds_read_b64_tr_b16 v[136:137], v152 offset:38912
    ds_read_b64_tr_b16 v[138:139], v152 offset:39424
    buffer_load_dwordx4 v4, s[48:51], s6 offen lds
    v_add_f32 v71, 1.0, v71
    v_rcp_f32 v64, v64
    s_waitcnt lgkmcnt(2)
    v_mfma_f32_32x32x16_bf16 v[80:95], v[116:119], a[100:103], v[80:95]
    ds_read_b64_tr_b16 v[140:141], v152 offset:39936
    ds_read_b64_tr_b16 v[142:143], v152 offset:40448
    v_rcp_f32 v65, v65
    v_rcp_f32 v66, v66
    v_rcp_f32 v67, v67
    s_add_u32 m0, s5, 122880
    v_mfma_f32_32x32x16_bf16 v[80:95], v[120:123], a[104:107], v[80:95]
    ds_read_b64_tr_b16 v[112:113], v157 offset:32768
    ds_read_b64_tr_b16 v[114:115], v157 offset:33280
    v_mov_b32 v7, s75
    s_waitcnt vmcnt(11)
    s_mov_b64 exec, 1
    s_cmp_eq_u32 s76, 0
    s_cbranch_scc1 L_slow_31
    buffer_store_dword v7, off, s[64:67], s8 offset:1024
L_join_32:
    s_mov_b64 exec, -1
    v_mfma_f32_32x32x16_bf16 v[80:95], v[124:127], a[108:111], v[80:95]
    ds_read_b64_tr_b16 v[116:117], v157 offset:33792
    ds_read_b64_tr_b16 v[118:119], v157 offset:34304
    buffer_load_dwordx4 v166, s[48:51], s6 offen lds
    v_rcp_f32_e64 v68, v68
    s_add_u32 m0, s5, 124928
    v_mfma_f32_32x32x16_bf16 v[80:95], v[128:131], a[112:115], v[80:95]
    ds_read_b64_tr_b16 v[120:121], v157 offset:34816
    ds_read_b64_tr_b16 v[122:123], v157 offset:35328
    v_rcp_f32 v69, v69
    v_rcp_f32 v70, v70
    s_add_u32 s6, s4, 65536
    v_mfma_f32_32x32x16_bf16 v[80:95], v[132:135], a[116:119], v[80:95]
    ds_read_b64_tr_b16 v[124:125], v157 offset:35840
    ds_read_b64_tr_b16 v[126:127], v157 offset:36352
    buffer_load_dwordx4 v4, s[48:51], s6 offen lds
    v_rcp_f32 v71, v71
    v_mul_f32 v64, v64, v72
    s_add_u32 m0, s5, 126976
    s_waitcnt lgkmcnt(4)
    v_mfma_f32_32x32x16_bf16 v[80:95], v[136:139], a[120:123], v[80:95]
    ds_read_b64_tr_b16 v[128:129], v157 offset:36864
    ds_read_b64_tr_b16 v[130:131], v157 offset:37376
    buffer_load_dwordx4 v166, s[48:51], s6 offen lds
    v_mul_f32 v65, v65, v73
    v_mul_f32 v66, v66, v74
    v_mul_f32 v67, v67, v75
    v_mul_f32_e64 v68, v68, v76
    v_mfma_f32_32x32x16_bf16 v[80:95], v[140:143], a[124:127], v[80:95]
    ds_read_b64_tr_b16 v[132:133], v157 offset:37888
    ds_read_b64_tr_b16 v[134:135], v157 offset:38400
    v_mul_f32 v69, v69, v77
    v_mul_f32 v70, v70, v78
    v_mul_f32_e64 v71, v71, v79
    v_cvt_pk_bf16_f32 v148, v64, v65
    v_cvt_pk_bf16_f32 v149, v66, v67
    v_cvt_pk_bf16_f32 v150, v68, v69
    s_add_u32 m0, s5, 129024
    v_mfma_f32_32x32x16_bf16 v[96:111], v[112:115], a[64:67], v[96:111]
    ds_read_b64_tr_b16 v[136:137], v157 offset:38912
    ds_read_b64_tr_b16 v[138:139], v157 offset:39424
    v_cvt_pk_bf16_f32 v151, v70, v71
    s_add_u32 s6, s4, 163840
    v_mfma_f32_32x32x16_bf16 v[96:111], v[116:119], a[68:71], v[96:111]
    ds_read_b64_tr_b16 v[140:141], v157 offset:39936
    ds_read_b64_tr_b16 v[142:143], v157 offset:40448
    buffer_load_dwordx4 v4, s[48:51], s6 offen lds
    buffer_store_dwordx4 v[148:151], v2, s[64:67], s15 offen offset:1024 sc1
    s_waitcnt lgkmcnt(4)
    v_mfma_f32_32x32x16_bf16 v[96:111], v[120:123], a[72:75], v[96:111]
    ds_read_b64_tr_b16 v[112:113], v153 offset:32768
    ds_read_b64_tr_b16 v[114:115], v153 offset:33280
    s_add_u32 s6, s17, 458752
    v_mfma_f32_32x32x16_bf16 v[96:111], v[124:127], a[76:79], v[96:111]
    ds_read_b64_tr_b16 v[116:117], v153 offset:33792
    ds_read_b64_tr_b16 v[118:119], v153 offset:34304
    buffer_load_dwordx4 a[152:155], v166, s[48:51], s6 offen
    v_exp_f32 v80, v80
    s_add_u32 s6, s17, 557056
    v_mfma_f32_32x32x16_bf16 v[96:111], v[128:131], a[80:83], v[96:111]
    ds_read_b64_tr_b16 v[120:121], v153 offset:34816
    ds_read_b64_tr_b16 v[122:123], v153 offset:35328
    buffer_load_dwordx4 a[156:159], v4, s[48:51], s6 offen
    v_exp_f32_e64 v81, v81
    v_mfma_f32_32x32x16_bf16 v[96:111], v[132:135], a[84:87], v[96:111]
    ds_read_b64_tr_b16 v[124:125], v153 offset:35840
    ds_read_b64_tr_b16 v[126:127], v153 offset:36352
    v_exp_f32 v82, v82
    v_exp_f32 v83, v83
    v_exp_f32_e64 v84, v84
    s_add_u32 s6, s17, 524288
    s_waitcnt lgkmcnt(4)
    v_mfma_f32_32x32x16_bf16 v[96:111], v[136:139], a[88:91], v[96:111]
    ds_read_b64_tr_b16 v[128:129], v153 offset:36864
    ds_read_b64_tr_b16 v[130:131], v153 offset:37376
    buffer_load_dword v159, v3, s[64:67], s74 offen offset:1024 sc1
    v_exp_f32 v85, v85
    v_exp_f32_e64 v86, v86
    v_mfma_f32_32x32x16_bf16 v[96:111], v[140:143], a[92:95], v[96:111]
    ds_read_b64_tr_b16 v[132:133], v153 offset:37888
    ds_read_b64_tr_b16 v[134:135], v153 offset:38400
    buffer_load_dwordx4 a[160:163], v166, s[48:51], s6 offen
    v_exp_f32 v87, v87
    v_add_f32 v80, 1.0, v80
    s_add_u32 s6, s17, 622592
    v_mfma_f32_32x32x16_bf16 v[96:111], v[112:115], a[96:99], v[96:111]
    ds_read_b64_tr_b16 v[136:137], v153 offset:38912
    ds_read_b64_tr_b16 v[138:139], v153 offset:39424
    buffer_load_dwordx4 a[164:167], v4, s[48:51], s6 offen
    v_add_f32 v81, 1.0, v81
    v_add_f32 v82, 1.0, v82
    v_add_f32_e64 v83, 1.0, v83
    v_mfma_f32_32x32x16_bf16 v[96:111], v[116:119], a[100:103], v[96:111]
    ds_read_b64_tr_b16 v[140:141], v153 offset:39936
    ds_read_b64_tr_b16 v[142:143], v153 offset:40448
    buffer_load_dwordx4 a[168:171], v166, s[48:51], s6 offen
    v_add_f32 v84, 1.0, v84
    v_add_f32 v85, 1.0, v85
    v_add_f32 v86, 1.0, v86
    v_add_f32 v87, 1.0, v87
    s_waitcnt lgkmcnt(2)
    v_mfma_f32_32x32x16_bf16 v[96:111], v[120:123], a[104:107], v[96:111]
    v_rcp_f32 v80, v80
    v_rcp_f32 v81, v81
    v_rcp_f32 v82, v82
    v_rcp_f32_e64 v83, v83
    v_mfma_f32_32x32x16_bf16 v[96:111], v[124:127], a[108:111], v[96:111]
    v_rcp_f32 v84, v84
    v_rcp_f32 v85, v85
    v_rcp_f32 v86, v86
    v_rcp_f32 v87, v87
    v_mul_f32_e64 v80, v80, v88
    v_mfma_f32_32x32x16_bf16 v[96:111], v[128:131], a[112:115], v[96:111]
    v_mul_f32 v81, v81, v89
    v_mul_f32 v82, v82, v90
    v_mul_f32 v83, v83, v91
    v_mul_f32 v84, v84, v92
    v_mul_f32 v85, v85, v93
    v_mul_f32 v86, v86, v94
    v_mul_f32_e64 v87, v87, v95
    v_cvt_pk_bf16_f32 v144, v80, v81
    v_mfma_f32_32x32x16_bf16 v[96:111], v[132:135], a[116:119], v[96:111]
    v_cvt_pk_bf16_f32 v145, v82, v83
    v_cvt_pk_bf16_f32 v146, v84, v85
    v_cvt_pk_bf16_f32 v147, v86, v87
    v_cmp_eq_u32 vcc, s75, v158
    s_nop 0
    s_and_b64 s[94:95], vcc, s[92:93]
    s_cmp_eq_u64 s[94:95], s[92:93]
    s_cbranch_scc0 L_f_33_r
L_f_33_ok:
    v_mfma_f32_32x32x16_bf16 v[96:111], v[136:139], a[120:123], v[96:111]
    s_cmp_eq_u32 s76, 0
    s_cbranch_scc1 L_slow_34
    buffer_store_dwordx4 v[144:147], v2, s[60:63], s16 offen offset:0
L_join_35:
    s_waitcnt lgkmcnt(0)
    v_mfma_f32_32x32x16_bf16 v[96:111], v[140:143], a[124:127], v[96:111]
    s_barrier
    s_waitcnt vmcnt(4)
    v_cmp_eq_u32 vcc, s75, v159
    s_nop 0
    s_and_b64 s[94:95], vcc, s[54:55]
    s_cmp_eq_u64 s[94:95], s[54:55]
    s_cbranch_scc0 L_f_36_r
L_f_36_ok:
    s_lshl_b32 s91, s78, 10
    s_add_u32 s91, s91, s27
    s_add_u32 s91, s91, 90112
    buffer_load_dwordx4 a[0:3], v2, s[64:67], s91 offen offset:0 sc1
    s_add_u32 s91, s53, 0
    buffer_load_dwordx4 a[4:7], v2, s[64:67], s91 offen offset:0 sc1
    buffer_load_dwordx4 a[8:11], v2, s[64:67], s91 offen offset:1024 sc1
    s_add_u32 s91, s53, 4096
    buffer_load_dwordx4 a[12:15], v2, s[64:67], s91 offen offset:0 sc1
    buffer_load_dwordx4 a[16:19], v2, s[64:67], s91 offen offset:1024 sc1
    s_add_u32 s91, s53, 8192
    buffer_load_dwordx4 a[20:23], v2, s[64:67], s91 offen offset:0 sc1
    ds_read_b64_tr_b16 v[48:49], v161 offset:0
    ds_read_b64_tr_b16 v[50:51], v161 offset:1024
    ds_read_b64_tr_b16 v[52:53], v160 offset:0
    ds_read_b64_tr_b16 v[54:55], v160 offset:1024
    ds_read_b64_tr_b16 v[56:57], v161 offset:2048
    ds_read_b64_tr_b16 v[58:59], v161 offset:3072
    ds_read_b64_tr_b16 v[60:61], v160 offset:2048
    ds_read_b64_tr_b16 v[62:63], v160 offset:3072
    ds_read_b64_tr_b16 v[64:65], v161 offset:4096
    ds_read_b64_tr_b16 v[66:67], v161 offset:5120
    ds_read_b64_tr_b16 v[68:69], v160 offset:4096
    ds_read_b64_tr_b16 v[70:71], v160 offset:5120
    ds_read_b64_tr_b16 v[72:73], v161 offset:6144
    ds_read_b64_tr_b16 v[74:75], v161 offset:7168
    ds_read_b64_tr_b16 v[76:77], v160 offset:6144
    ds_read_b64_tr_b16 v[78:79], v160 offset:7168
    v_exp_f32 v96, v96
    v_exp_f32 v97, v97
    v_exp_f32 v98, v98
    v_exp_f32 v99, v99
    v_exp_f32 v100, v100
    v_exp_f32 v101, v101
    v_exp_f32 v102, v102
    v_exp_f32 v103, v103
    v_add_f32 v96, 1.0, v96
    v_add_f32 v97, 1.0, v97
    v_add_f32 v98, 1.0, v98
    v_add_f32 v99, 1.0, v99
    v_add_f32 v100, 1.0, v100
    v_add_f32 v101, 1.0, v101
    v_add_f32 v102, 1.0, v102
    v_add_f32 v103, 1.0, v103
    v_rcp_f32 v96, v96
    v_rcp_f32 v97, v97
    v_rcp_f32 v98, v98
    v_rcp_f32 v99, v99
    v_rcp_f32 v100, v100
    v_rcp_f32 v101, v101
    v_rcp_f32 v102, v102
    v_rcp_f32 v103, v103
    v_mul_f32 v96, v96, v104
    v_mul_f32 v97, v97, v105
    v_mul_f32 v98, v98, v106
    v_mul_f32 v99, v99, v107
    v_mul_f32 v100, v100, v108
    v_mul_f32 v101, v101, v109
    v_mul_f32 v102, v102, v110
    v_mul_f32 v103, v103, v111
    v_cvt_pk_bf16_f32 v148, v96, v97
    v_cvt_pk_bf16_f32 v149, v98, v99
    v_cvt_pk_bf16_f32 v150, v100, v101
    v_cvt_pk_bf16_f32 v151, v102, v103
    s_cmp_eq_u32 s76, 0
    s_cbranch_scc1 L_slow_37
    buffer_store_dwordx4 v[148:151], v2, s[60:63], s16 offen offset:1024
L_join_38:
    v_mov_b32 v7, s75
    s_mov_b64 exec, 1
    s_cmp_eq_u32 s76, 0
    s_cbranch_scc1 L_slow_39
    buffer_store_dword v7, off, s[64:67], s8 offset:768
L_join_40:
    s_mov_b64 exec, -1
    s_waitcnt vmcnt(7) lgkmcnt(0)
    v_mfma_f32_32x32x16_bf16 v[32:47], v[48:51], a[0:3], 0
    ds_read_b64_tr_b16 v[80:81], v161 offset:8192
    ds_read_b64_tr_b16 v[82:83], v161 offset:9216
    buffer_load_dwordx4 a[24:27], v2, s[64:67], s91 offen offset:1024 sc1
    v_mfma_f32_32x32x16_bf16 v[16:31], v[52:55], a[0:3], 0
    ds_read_b64_tr_b16 v[84:85], v160 offset:8192
    ds_read_b64_tr_b16 v[86:87], v160 offset:9216
    s_add_u32 s91, s53, 12288
    s_waitcnt vmcnt(7)
    v_mfma_f32_32x32x16_bf16 v[32:47], v[56:59], a[4:7], v[32:47]
    ds_read_b64_tr_b16 v[88:89], v161 offset:10240
    ds_read_b64_tr_b16 v[90:91], v161 offset:11264
    buffer_load_dwordx4 a[28:31], v2, s[64:67], s91 offen offset:0 sc1
    v_mfma_f32_32x32x16_bf16 v[16:31], v[60:63], a[4:7], v[16:31]
    ds_read_b64_tr_b16 v[92:93], v160 offset:10240
    ds_read_b64_tr_b16 v[94:95], v160 offset:11264
    buffer_load_dwordx4 a[32:35], v2, s[64:67], s91 offen offset:1024 sc1
    s_waitcnt vmcnt(8)
    v_mfma_f32_32x32x16_bf16 v[32:47], v[64:67], a[8:11], v[32:47]
    ds_read_b64_tr_b16 v[48:49], v161 offset:12288
    ds_read_b64_tr_b16 v[50:51], v161 offset:13312
    s_add_u32 s91, s53, 16384
    s_add_u32 s88, s20, 131072
    v_mfma_f32_32x32x16_bf16 v[16:31], v[68:71], a[8:11], v[16:31]
    ds_read_b64_tr_b16 v[52:53], v160 offset:12288
    ds_read_b64_tr_b16 v[54:55], v160 offset:13312
    buffer_load_dwordx4 a[36:39], v2, s[64:67], s91 offen offset:0 sc1
    v_add_u32_e64 v168, s88, v2
    s_add_u32 s88, s18, 49152
    s_waitcnt vmcnt(8)
    v_mfma_f32_32x32x16_bf16 v[32:47], v[72:75], a[12:15], v[32:47]
    ds_read_b64_tr_b16 v[56:57], v161 offset:14336
    ds_read_b64_tr_b16 v[58:59], v161 offset:15360
    buffer_load_dwordx4 a[40:43], v2, s[64:67], s91 offen offset:1024 sc1
    v_add_u32 v169, s88, v2
    v_mfma_f32_32x32x16_bf16 v[16:31], v[76:79], a[12:15], v[16:31]
    ds_read_b64_tr_b16 v[60:61], v160 offset:14336
    ds_read_b64_tr_b16 v[62:63], v160 offset:15360
    ds_write_b128 v168, a[128:131] offset:0
    s_add_u32 s91, s53, 20480
    s_waitcnt vmcnt(8) lgkmcnt(6)
    v_mfma_f32_32x32x16_bf16 v[32:47], v[80:83], a[16:19], v[32:47]
    ds_read_b64_tr_b16 v[64:65], v161 offset:16384
    ds_read_b64_tr_b16 v[66:67], v161 offset:17408
    buffer_load_dwordx4 a[44:47], v2, s[64:67], s91 offen offset:0 sc1
    v_mfma_f32_32x32x16_bf16 v[16:31], v[84:87], a[16:19], v[16:31]
    ds_read_b64_tr_b16 v[68:69], v160 offset:16384
    ds_read_b64_tr_b16 v[70:71], v160 offset:17408
    buffer_load_dwordx4 a[48:51], v2, s[64:67], s91 offen offset:1024 sc1
    s_waitcnt vmcnt(9)
    v_mfma_f32_32x32x16_bf16 v[32:47], v[88:91], a[20:23], v[32:47]
    ds_read_b64_tr_b16 v[72:73], v161 offset:18432
    ds_read_b64_tr_b16 v[74:75], v161 offset:19456
    buffer_load_dword v159, v3, s[64:67], s74 offen offset:768 sc1
    v_mov_b32 v7, s75
    s_waitcnt vmcnt(9)
    s_mov_b64 exec, 1
    s_cmp_eq_u32 s76, 0
    s_cbranch_scc1 L_slow_41
    buffer_store_dword v7, off, s[64:67], s8 offset:512
L_join_42:
    s_mov_b64 exec, -1
    v_mfma_f32_32x32x16_bf16 v[16:31], v[92:95], a[20:23], v[16:31]
    ds_read_b64_tr_b16 v[76:77], v160 offset:18432
    ds_read_b64_tr_b16 v[78:79], v160 offset:19456
    ds_write_b128 v168, a[132:135] offset:2048
    s_add_u32 s91, s53, 24576
    s_waitcnt vmcnt(8)
    v_mfma_f32_32x32x16_bf16 v[32:47], v[48:51], a[24:27], v[32:47]
    ds_read_b64_tr_b16 v[80:81], v161 offset:20480
    ds_read_b64_tr_b16 v[82:83], v161 offset:21504
    buffer_load_dwordx4 a[52:55], v2, s[64:67], s91 offen offset:0 sc1
    s_waitcnt lgkmcnt(5)
    v_mfma_f32_32x32x16_bf16 v[16:31], v[52:55], a[24:27], v[16:31]
    ds_read_b64_tr_b16 v[84:85], v160 offset:20480
    ds_read_b64_tr_b16 v[86:87], v160 offset:21504
    buffer_load_dwordx4 a[56:59], v2, s[64:67], s91 offen offset:1024 sc1
    s_waitcnt vmcnt(9)
    v_mfma_f32_32x32x16_bf16 v[32:47], v[56:59], a[28:31], v[32:47]
    ds_read_b64_tr_b16 v[88:89], v161 offset:22528
    ds_read_b64_tr_b16 v[90:91], v161 offset:23552
    ds_write_b128 v168, a[136:139] offset:4096
    v_mfma_f32_32x32x16_bf16 v[16:31], v[60:63], a[28:31], v[16:31]
    ds_read_b64_tr_b16 v[92:93], v160 offset:22528
    ds_read_b64_tr_b16 v[94:95], v160 offset:23552
    ds_write_b128 v168, a[140:143] offset:6144
    s_waitcnt vmcnt(8)
    v_mfma_f32_32x32x16_bf16 v[32:47], v[64:67], a[32:35], v[32:47]
    s_waitcnt vmcnt(3)
    v_cmp_eq_u32 vcc, s75, v159
    s_nop 0
    s_and_b64 s[94:95], vcc, s[54:55]
    s_cmp_eq_u64 s[94:95], s[54:55]
    s_cbranch_scc0 L_f_43_r
L_f_43_ok:
    ds_read_b64_tr_b16 v[48:49], v163 offset:0
    ds_read_b64_tr_b16 v[50:51], v163 offset:1024
    v_mfma_f32_32x32x16_bf16 v[16:31], v[68:71], a[32:35], v[16:31]
    ds_read_b64_tr_b16 v[52:53], v162 offset:0
    ds_read_b64_tr_b16 v[54:55], v162 offset:1024
    ds_write_b128 v168, a[144:147] offset:8192
    s_add_u32 s91, s53, 0
    v_mfma_f32_32x32x16_bf16 v[32:47], v[72:75], a[36:39], v[32:47]
    ds_read_b64_tr_b16 v[56:57], v163 offset:2048
    ds_read_b64_tr_b16 v[58:59], v163 offset:3072
    buffer_load_dwordx4 a[60:63], v2, s[64:67], s91 offen offset:2048 sc1
    s_waitcnt lgkmcnt(7)
    v_mfma_f32_32x32x16_bf16 v[16:31], v[76:79], a[36:39], v[16:31]
    ds_read_b64_tr_b16 v[60:61], v162 offset:2048
    ds_read_b64_tr_b16 v[62:63], v162 offset:3072
    buffer_load_dwordx4 a[64:67], v2, s[64:67], s91 offen offset:3072 sc1
    v_mfma_f32_32x32x16_bf16 v[32:47], v[80:83], a[40:43], v[32:47]
    ds_read_b64_tr_b16 v[64:65], v163 offset:4096
    ds_read_b64_tr_b16 v[66:67], v163 offset:5120
    ds_write_b128 v168, a[148:151] offset:10240
    s_add_u32 s91, s53, 4096
    v_mfma_f32_32x32x16_bf16 v[16:31], v[84:87], a[40:43], v[16:31]
    ds_read_b64_tr_b16 v[68:69], v162 offset:4096
    ds_read_b64_tr_b16 v[70:71], v162 offset:5120
    buffer_load_dwordx4 a[68:71], v2, s[64:67], s91 offen offset:2048 sc1
    v_mfma_f32_32x32x16_bf16 v[32:47], v[88:91], a[44:47], v[32:47]
    ds_read_b64_tr_b16 v[72:73], v163 offset:6144
    ds_read_b64_tr_b16 v[74:75], v163 offset:7168
    buffer_load_dwordx4 a[72:75], v2, s[64:67], s91 offen offset:3072 sc1
    v_mfma_f32_32x32x16_bf16 v[16:31], v[92:95], a[44:47], v[16:31]
    ds_read_b64_tr_b16 v[76:77], v162 offset:6144
    ds_read_b64_tr_b16 v[78:79], v162 offset:7168
    ds_write_b128 v168, a[152:155] offset:12288
    s_add_u32 s91, s53, 8192
    s_waitcnt lgkmcnt(7)
    v_mfma_f32_32x32x16_bf16 v[32:47], v[48:51], a[48:51], v[32:47]
    ds_read_b64_tr_b16 v[80:81], v163 offset:8192
    ds_read_b64_tr_b16 v[82:83], v163 offset:9216
    buffer_load_dwordx4 a[76:79], v2, s[64:67], s91 offen offset:2048 sc1
    v_mfma_f32_32x32x16_bf16 v[16:31], v[52:55], a[48:51], v[16:31]
    ds_read_b64_tr_b16 v[84:85], v162 offset:8192
    ds_read_b64_tr_b16 v[86:87], v162 offset:9216
    buffer_load_dwordx4 a[80:83], v2, s[64:67], s91 offen offset:3072 sc1
    s_waitcnt vmcnt(7)
    v_mfma_f32_32x32x16_bf16 v[32:47], v[56:59], a[52:55], v[32:47]
    ds_read_b64_tr_b16 v[88:89], v163 offset:10240
    ds_read_b64_tr_b16 v[90:91], v163 offset:11264
    ds_write_b128 v168, a[156:159] offset:14336
    s_add_u32 s91, s53, 12288
    v_mfma_f32_32x32x16_bf16 v[16:31], v[60:63], a[52:55], v[16:31]
    ds_read_b64_tr_b16 v[92:93], v162 offset:10240
    ds_read_b64_tr_b16 v[94:95], v162 offset:11264
    s_waitcnt vmcnt(6)
    v_mfma_f32_32x32x16_bf16 v[32:47], v[64:67], a[56:59], v[32:47]
    ds_read_b64_tr_b16 v[48:49], v163 offset:12288
    ds_read_b64_tr_b16 v[50:51], v163 offset:13312
    buffer_load_dwordx4 a[84:87], v2, s[64:67], s91 offen offset:2048 sc1
    s_waitcnt lgkmcnt(8)
    v_mfma_f32_32x32x16_bf16 v[16:31], v[68:71], a[56:59], v[16:31]
    ds_read_b64_tr_b16 v[52:53], v162 offset:12288
    ds_read_b64_tr_b16 v[54:55], v162 offset:13312
    buffer_load_dwordx4 a[88:91], v2, s[64:67], s91 offen offset:3072 sc1
    s_waitcnt vmcnt(7)
    v_mfma_f32_32x32x16_bf16 v[32:47], v[72:75], a[60:63], v[32:47]
    ds_read_b64_tr_b16 v[56:57], v163 offset:14336
    ds_read_b64_tr_b16 v[58:59], v163 offset:15360
    buffer_load_dword v158, v3, s[64:67], s74 offen offset:512 sc1
    s_add_u32 s91, s53, 16384
    v_mfma_f32_32x32x16_bf16 v[16:31], v[76:79], a[60:63], v[16:31]
    s_waitcnt lgkmcnt(8)
    s_barrier
    ds_read_b64_tr_b16 v[60:61], v162 offset:14336
    ds_read_b64_tr_b16 v[62:63], v162 offset:15360
    buffer_load_dwordx4 a[92:95], v2, s[64:67], s91 offen offset:2048 sc1
    s_waitcnt vmcnt(8)
    v_mfma_f32_32x32x16_bf16 v[32:47], v[80:83], a[64:67], v[32:47]
    ds_read_b64_tr_b16 v[64:65], v163 offset:16384
    ds_read_b64_tr_b16 v[66:67], v163 offset:17408
    buffer_load_dwordx4 a[96:99], v2, s[64:67], s91 offen offset:3072 sc1
    v_mfma_f32_32x32x16_bf16 v[16:31], v[84:87], a[64:67], v[16:31]
    ds_read_b64_tr_b16 v[68:69], v162 offset:16384
    ds_read_b64_tr_b16 v[70:71], v162 offset:17408
    ds_write_b128 v169, a[160:163] offset:0
    s_waitcnt vmcnt(8)
    v_mfma_f32_32x32x16_bf16 v[32:47], v[88:91], a[68:71], v[32:47]
    ds_read_b64_tr_b16 v[72:73], v163 offset:18432
    ds_read_b64_tr_b16 v[74:75], v163 offset:19456
    ds_write_b128 v169, a[164:167] offset:2048
    s_waitcnt lgkmcnt(9)
    v_mfma_f32_32x32x16_bf16 v[16:31], v[92:95], a[68:71], v[16:31]
    ds_read_b64_tr_b16 v[76:77], v162 offset:18432
    ds_read_b64_tr_b16 v[78:79], v162 offset:19456
    ds_write_b128 v169, a[168:171] offset:4096
    s_waitcnt vmcnt(7)
    v_mfma_f32_32x32x16_bf16 v[32:47], v[48:51], a[72:75], v[32:47]
    s_waitcnt vmcnt(2)
    v_cmp_eq_u32 vcc, s75, v158
    s_nop 0
    s_and_b64 s[94:95], vcc, s[54:55]
    s_cmp_eq_u64 s[94:95], s[54:55]
    s_cbranch_scc0 L_f_44_r
L_f_44_ok:
    ds_read_b64_tr_b16 v[80:81], v163 offset:20480
    ds_read_b64_tr_b16 v[82:83], v163 offset:21504
    v_mfma_f32_32x32x16_bf16 v[16:31], v[52:55], a[72:75], v[16:31]
    ds_read_b64_tr_b16 v[84:85], v162 offset:20480
    ds_read_b64_tr_b16 v[86:87], v162 offset:21504
    s_add_u32 s91, s26, 0
    v_mfma_f32_32x32x16_bf16 v[32:47], v[56:59], a[76:79], v[32:47]
    ds_read_b64_tr_b16 v[88:89], v163 offset:22528
    ds_read_b64_tr_b16 v[90:91], v163 offset:23552
    buffer_load_dwordx4 a[100:103], v2, s[60:63], s91 offen offset:0 sc1
    s_waitcnt lgkmcnt(6)
    v_mfma_f32_32x32x16_bf16 v[16:31], v[60:63], a[76:79], v[16:31]
    ds_read_b64_tr_b16 v[92:93], v162 offset:22528
    ds_read_b64_tr_b16 v[94:95], v162 offset:23552
    buffer_load_dwordx4 a[104:107], v2, s[60:63], s91 offen offset:1024 sc1
    v_mfma_f32_32x32x16_bf16 v[32:47], v[64:67], a[80:83], v[32:47]
    ds_read_b64_tr_b16 v[48:49], v163 offset:24576
    ds_read_b64_tr_b16 v[50:51], v163 offset:25600
    buffer_load_dwordx4 a[108:111], v2, s[60:63], s91 offen offset:2048 sc1
    v_mfma_f32_32x32x16_bf16 v[16:31], v[68:71], a[80:83], v[16:31]
    ds_read_b64_tr_b16 v[52:53], v162 offset:24576
    ds_read_b64_tr_b16 v[54:55], v162 offset:25600
    buffer_load_dwordx4 a[112:115], v2, s[60:63], s91 offen offset:3072 sc1
    v_mfma_f32_32x32x16_bf16 v[32:47], v[72:75], a[84:87], v[32:47]
    ds_read_b64_tr_b16 v[56:57], v163 offset:26624
    ds_read_b64_tr_b16 v[58:59], v163 offset:27648
    v_mfma_f32_32x32x16_bf16 v[16:31], v[76:79], a[84:87], v[16:31]
    ds_read_b64_tr_b16 v[60:61], v162 offset:26624
    ds_read_b64_tr_b16 v[62:63], v162 offset:27648
    s_add_u32 s91, s26, 4096
    s_waitcnt lgkmcnt(8)
    v_mfma_f32_32x32x16_bf16 v[32:47], v[80:83], a[88:91], v[32:47]
    ds_read_b64_tr_b16 v[64:65], v163 offset:28672
    ds_read_b64_tr_b16 v[66:67], v163 offset:29696
    buffer_load_dwordx4 a[116:119], v2, s[60:63], s91 offen offset:0 sc1
    v_mfma_f32_32x32x16_bf16 v[16:31], v[84:87], a[88:91], v[16:31]
    ds_read_b64_tr_b16 v[68:69], v162 offset:28672
    ds_read_b64_tr_b16 v[70:71], v162 offset:29696
    buffer_load_dwordx4 a[120:123], v2, s[60:63], s91 offen offset:1024 sc1
    s_waitcnt vmcnt(7)
    v_mfma_f32_32x32x16_bf16 v[32:47], v[88:91], a[92:95], v[32:47]
    ds_read_b64_tr_b16 v[72:73], v163 offset:30720
    ds_read_b64_tr_b16 v[74:75], v163 offset:31744
    v_mfma_f32_32x32x16_bf16 v[16:31], v[92:95], a[92:95], v[16:31]
    ds_read_b64_tr_b16 v[76:77], v162 offset:30720
    ds_read_b64_tr_b16 v[78:79], v162 offset:31744
    buffer_load_dwordx4 a[124:127], v2, s[60:63], s91 offen offset:2048 sc1
    s_waitcnt vmcnt(7) lgkmcnt(8)
    v_mfma_f32_32x32x16_bf16 v[32:47], v[48:51], a[96:99], v[32:47]
    ds_read_b64_tr_b16 v[80:81], v163 offset:32768
    ds_read_b64_tr_b16 v[82:83], v163 offset:33792
    buffer_load_dwordx4 a[128:131], v2, s[60:63], s91 offen offset:3072 sc1
    v_mfma_f32_32x32x16_bf16 v[16:31], v[52:55], a[96:99], v[16:31]
    ds_read_b64_tr_b16 v[84:85], v162 offset:32768
    ds_read_b64_tr_b16 v[86:87], v162 offset:33792
    s_waitcnt vmcnt(7)
    v_mfma_f32_32x32x16_bf16 v[32:47], v[56:59], a[100:103], v[32:47]
    ds_read_b64_tr_b16 v[88:89], v163 offset:34816
    ds_read_b64_tr_b16 v[90:91], v163 offset:35840
    s_add_u32 s91, s26, 8192
    v_mfma_f32_32x32x16_bf16 v[16:31], v[60:63], a[100:103], v[16:31]
    ds_read_b64_tr_b16 v[92:93], v162 offset:34816
    ds_read_b64_tr_b16 v[94:95], v162 offset:35840
    buffer_load_dwordx4 a[132:135], v2, s[60:63], s91 offen offset:0 sc1
    s_waitcnt vmcnt(7) lgkmcnt(8)
    v_mfma_f32_32x32x16_bf16 v[32:47], v[64:67], a[104:107], v[32:47]
    ds_read_b64_tr_b16 v[48:49], v163 offset:36864
    ds_read_b64_tr_b16 v[50:51], v163 offset:37888
    v_mfma_f32_32x32x16_bf16 v[16:31], v[68:71], a[104:107], v[16:31]
    ds_read_b64_tr_b16 v[52:53], v162 offset:36864
    ds_read_b64_tr_b16 v[54:55], v162 offset:37888
    buffer_load_dwordx4 a[136:139], v2, s[60:63], s91 offen offset:1024 sc1
    s_waitcnt vmcnt(7)
    v_mfma_f32_32x32x16_bf16 v[32:47], v[72:75], a[108:111], v[32:47]
    ds_read_b64_tr_b16 v[56:57], v163 offset:38912
    ds_read_b64_tr_b16 v[58:59], v163 offset:39936
    buffer_load_dwordx4 a[140:143], v2, s[60:63], s91 offen offset:2048 sc1
    v_mfma_f32_32x32x16_bf16 v[16:31], v[76:79], a[108:111], v[16:31]
    ds_read_b64_tr_b16 v[60:61], v162 offset:38912
    ds_read_b64_tr_b16 v[62:63], v162 offset:39936
    buffer_load_dwordx4 a[144:147], v2, s[60:63], s91 offen offset:3072 sc1
    s_waitcnt vmcnt(8) lgkmcnt(8)
    v_mfma_f32_32x32x16_bf16 v[32:47], v[80:83], a[112:115], v[32:47]
    s_barrier
    ds_read_b64_tr_b16 v[64:65], v163 offset:40960
    ds_read_b64_tr_b16 v[66:67], v163 offset:41984
    v_mfma_f32_32x32x16_bf16 v[16:31], v[84:87], a[112:115], v[16:31]
    ds_read_b64_tr_b16 v[68:69], v162 offset:40960
    ds_read_b64_tr_b16 v[70:71], v162 offset:41984
    s_add_u32 s91, s26, 12288
    s_waitcnt vmcnt(7)
    v_mfma_f32_32x32x16_bf16 v[32:47], v[88:91], a[116:119], v[32:47]
    ds_read_b64_tr_b16 v[72:73], v163 offset:43008
    ds_read_b64_tr_b16 v[74:75], v163 offset:44032
    buffer_load_dwordx4 a[148:151], v2, s[60:63], s91 offen offset:0 sc1
    v_mfma_f32_32x32x16_bf16 v[16:31], v[92:95], a[116:119], v[16:31]
    ds_read_b64_tr_b16 v[76:77], v162 offset:43008
    ds_read_b64_tr_b16 v[78:79], v162 offset:44032
    s_waitcnt vmcnt(7) lgkmcnt(8)
    v_mfma_f32_32x32x16_bf16 v[32:47], v[48:51], a[120:123], v[32:47]
    ds_read_b64_tr_b16 v[80:81], v163 offset:45056
    ds_read_b64_tr_b16 v[82:83], v163 offset:46080
    buffer_load_dwordx4 a[152:155], v2, s[60:63], s91 offen offset:1024 sc1
    v_mfma_f32_32x32x16_bf16 v[16:31], v[52:55], a[120:123], v[16:31]
    ds_read_b64_tr_b16 v[84:85], v162 offset:45056
    ds_read_b64_tr_b16 v[86:87], v162 offset:46080
    s_add_u32 s91, s53, 20480
    s_mov_b32 s100, 0x55555555
    s_waitcnt vmcnt(7)
    v_mfma_f32_32x32x16_bf16 v[32:47], v[56:59], a[124:127], v[32:47]
    ds_read_b64_tr_b16 v[88:89], v163 offset:47104
    ds_read_b64_tr_b16 v[90:91], v163 offset:48128
    buffer_load_dwordx4 a[156:159], v2, s[64:67], s91 offen offset:2048 sc1
    v_mfma_f32_32x32x16_bf16 v[16:31], v[60:63], a[124:127], v[16:31]
    ds_read_b64_tr_b16 v[92:93], v162 offset:47104
    ds_read_b64_tr_b16 v[94:95], v162 offset:48128
    s_mov_b32 s101, 0
    s_lshl_b32 s89, s99, 4
    s_waitcnt vmcnt(7) lgkmcnt(6)
    v_mfma_f32_32x32x16_bf16 v[32:47], v[64:67], a[128:131], v[32:47]
    ds_read_b64_tr_b16 v[48:49], v165 offset:0
    ds_read_b64_tr_b16 v[50:51], v165 offset:1024
    buffer_load_dwordx4 a[160:163], v2, s[64:67], s91 offen offset:3072 sc1
    v_mfma_f32_32x32x16_bf16 v[16:31], v[68:71], a[128:131], v[16:31]
    ds_read_b64_tr_b16 v[52:53], v164 offset:0
    ds_read_b64_tr_b16 v[54:55], v164 offset:1024
    s_add_u32 s91, s53, 24576
    s_add_u32 s89, s89, s77
    s_waitcnt vmcnt(7)
    v_mfma_f32_32x32x16_bf16 v[32:47], v[72:75], a[132:135], v[32:47]
    ds_read_b64_tr_b16 v[56:57], v165 offset:2048
    ds_read_b64_tr_b16 v[58:59], v165 offset:3072
    s_lshl_b64 s[92:93], s[100:101], s89
    v_mfma_f32_32x32x16_bf16 v[16:31], v[76:79], a[132:135], v[16:31]
    ds_read_b64_tr_b16 v[60:61], v164 offset:2048
    ds_read_b64_tr_b16 v[62:63], v164 offset:3072
    buffer_load_dwordx4 a[164:167], v2, s[64:67], s91 offen offset:2048 sc1
    s_waitcnt vmcnt(7)
    v_mfma_f32_32x32x16_bf16 v[32:47], v[80:83], a[136:139], v[32:47]
    ds_read_b64_tr_b16 v[64:65], v165 offset:4096
    ds_read_b64_tr_b16 v[66:67], v165 offset:5120
    buffer_load_dwordx4 a[168:171], v2, s[64:67], s91 offen offset:3072 sc1
    s_waitcnt lgkmcnt(6)
    v_mfma_f32_32x32x16_bf16 v[16:31], v[84:87], a[136:139], v[16:31]
    ds_read_b64_tr_b16 v[68:69], v164 offset:4096
    ds_read_b64_tr_b16 v[70:71], v164 offset:5120
    s_waitcnt vmcnt(7)
    v_mfma_f32_32x32x16_bf16 v[32:47], v[88:91], a[140:143], v[32:47]
    ds_read_b64_tr_b16 v[72:73], v165 offset:6144
    ds_read_b64_tr_b16 v[74:75], v165 offset:7168
    v_accvgpr_read_b32 v10, a222
    s_lshl_b32 s88, s68, 12
    v_mfma_f32_32x32x16_bf16 v[16:31], v[92:95], a[140:143], v[16:31]
    ds_read_b64_tr_b16 v[76:77], v164 offset:6144
    ds_read_b64_tr_b16 v[78:79], v164 offset:7168
    s_add_u32 s88, s88, 147456
    s_waitcnt vmcnt(6)
    v_mfma_f32_32x32x16_bf16 v[32:47], v[48:51], a[144:147], v[32:47]
    ds_read_b64_tr_b16 v[80:81], v161 offset:0
    ds_read_b64_tr_b16 v[82:83], v161 offset:1024
    v_add_u32 v8, s88, v2
    v_mfma_f32_32x32x16_bf16 v[16:31], v[52:55], a[144:147], v[16:31]
    ds_read_b64_tr_b16 v[84:85], v160 offset:0
    ds_read_b64_tr_b16 v[86:87], v160 offset:1024
    v_xor_b32 v9, 8192, v8
    v_accvgpr_read_b32 v96, a240
    s_waitcnt vmcnt(5) lgkmcnt(6)
    v_mfma_f32_32x32x16_bf16 v[32:47], v[56:59], a[148:151], v[32:47]
    ds_read_b64_tr_b16 v[88:89], v161 offset:2048
    ds_read_b64_tr_b16 v[90:91], v161 offset:3072
    v_accvgpr_read_b32 v97, a241
    v_mfma_f32_32x32x16_bf16 v[16:31], v[60:63], a[148:151], v[16:31]
    ds_read_b64_tr_b16 v[92:93], v160 offset:2048
    ds_read_b64_tr_b16 v[94:95], v160 offset:3072
    v_accvgpr_read_b32 v98, a242
    s_waitcnt vmcnt(4)
    v_mfma_f32_32x32x16_bf16 v[32:47], v[64:67], a[152:155], v[32:47]
    ds_read_b64_tr_b16 v[48:49], v161 offset:4096
    ds_read_b64_tr_b16 v[50:51], v161 offset:5120
    v_accvgpr_read_b32 v99, a243
    v_accvgpr_read_b32 v100, a244
    v_mfma_f32_32x32x16_bf16 v[16:31], v[68:71], a[152:155], v[16:31]
    ds_read_b64_tr_b16 v[52:53], v160 offset:4096
    ds_read_b64_tr_b16 v[54:55], v160 offset:5120
    v_mov_b32 v7, s75
    s_mov_b64 exec, 1
    s_cmp_eq_u32 s76, 0
    s_cbranch_scc1 L_slow_45
    buffer_store_dword v7, off, s[64:67], s8 offset:1536
L_join_46:
    s_mov_b64 exec, -1
    s_waitcnt vmcnt(4)
    v_mfma_f32_32x32x16_bf16 v[32:47], v[72:75], a[156:159], v[32:47]
    v_accvgpr_read_b32 v101, a245
    v_accvgpr_read_b32 v102, a246
    s_waitcnt lgkmcnt(3)
    v_mfma_f32_32x32x16_bf16 v[16:31], v[76:79], a[156:159], v[16:31]
    v_accvgpr_read_b32 v103, a247
    v_accvgpr_read_b32 v104, a248
    s_waitcnt vmcnt(3)
    v_mfma_f32_32x32x16_bf16 v[32:47], v[80:83], a[160:163], v[32:47]
    s_barrier
    v_accvgpr_read_b32 v105, a249
    v_mfma_f32_32x32x16_bf16 v[16:31], v[84:87], a[160:163], v[16:31]
    v_accvgpr_read_b32 v106, a250
    s_waitcnt vmcnt(2)
    v_mfma_f32_32x32x16_bf16 v[32:47], v[88:91], a[164:167], v[32:47]
    v_accvgpr_read_b32 v107, a251
    v_accvgpr_read_b32 v108, a252
    v_mfma_f32_32x32x16_bf16 v[16:31], v[92:95], a[164:167], v[16:31]
    v_accvgpr_read_b32 v109, a253
    s_waitcnt vmcnt(1) lgkmcnt(0)
    v_mfma_f32_32x32x16_bf16 v[32:47], v[48:51], a[168:171], v[32:47]
    v_accvgpr_read_b32 v110, a254
    v_mfma_f32_32x32x16_bf16 v[16:31], v[52:55], a[168:171], v[16:31]
    v_accvgpr_read_b32 v111, a255
    s_nop 8
    ds_write_b128 v8, v[32:35] offset:0
    ds_write_b128 v8, v[36:39] offset:1024
    ds_write_b128 v8, v[40:43] offset:2048
    ds_write_b128 v8, v[44:47] offset:3072
    buffer_load_dword v159, v3, s[64:67], s74 offen offset:1536 sc1
    s_waitcnt lgkmcnt(0)
    s_barrier
    ds_read_b128 v[48:51], v9 offset:0
    ds_read_b128 v[52:55], v9 offset:1024
    ds_read_b128 v[56:59], v9 offset:2048
    ds_read_b128 v[60:63], v9 offset:3072
    v_pk_fma_f32 v[240:241], v[16:17], v[96:97], v[240:241]
    v_pk_fma_f32 v[242:243], v[18:19], v[98:99], v[242:243]
    v_pk_fma_f32 v[244:245], v[20:21], v[100:101], v[244:245]
    v_pk_fma_f32 v[246:247], v[22:23], v[102:103], v[246:247]
    v_pk_fma_f32 v[248:249], v[24:25], v[104:105], v[248:249]
    v_pk_fma_f32 v[250:251], v[26:27], v[106:107], v[250:251]
    v_pk_fma_f32 v[252:253], v[28:29], v[108:109], v[252:253]
    v_pk_fma_f32 v[254:255], v[30:31], v[110:111], v[254:255]
    s_waitcnt lgkmcnt(3)
    v_pk_fma_f32 v[16:17], v[48:49], v[96:97], v[240:241]
    v_pk_fma_f32 v[18:19], v[50:51], v[98:99], v[242:243]
    s_waitcnt lgkmcnt(2)
    v_pk_fma_f32 v[20:21], v[52:53], v[100:101], v[244:245]
    v_pk_fma_f32 v[22:23], v[54:55], v[102:103], v[246:247]
    v_cvt_pk_bf16_f32 v32, v16, v17
    v_cvt_pk_bf16_f32 v33, v18, v19
    v_cvt_pk_bf16_f32 v34, v20, v21
    v_cvt_pk_bf16_f32 v35, v22, v23
    s_nop 0
    v_permlane32_swap_b32 v32, v34
    v_permlane32_swap_b32 v33, v35
    s_waitcnt vmcnt(0)
    v_cmp_eq_u32 vcc, s75, v159
    s_nop 0
    s_and_b64 s[94:95], vcc, s[92:93]
    s_cmp_eq_u64 s[94:95], s[92:93]
    s_cbranch_scc0 L_f_47_r
L_f_47_ok:
    buffer_store_dwordx4 v[32:35], v10, s[60:63], s97 offen offset:0
    s_waitcnt lgkmcnt(1)
    v_pk_fma_f32 v[24:25], v[56:57], v[104:105], v[248:249]
    v_pk_fma_f32 v[26:27], v[58:59], v[106:107], v[250:251]
    s_waitcnt lgkmcnt(0)
    s_nop 0
    v_pk_fma_f32 v[28:29], v[60:61], v[108:109], v[252:253]
    v_pk_fma_f32 v[30:31], v[62:63], v[110:111], v[254:255]
    v_cvt_pk_bf16_f32 v36, v24, v25
    v_cvt_pk_bf16_f32 v37, v26, v27
    v_cvt_pk_bf16_f32 v38, v28, v29
    v_cvt_pk_bf16_f32 v39, v30, v31
    s_nop 0
    v_permlane32_swap_b32 v36, v38
    v_permlane32_swap_b32 v37, v39
    buffer_store_dwordx4 v[36:39], v10, s[60:63], s97 offen offset:32
L_end:
    s_endpgm
L_codeend:
L_mretry_8:
    s_sleep 4
    s_mov_b32 s13, 65536
    buffer_load_dwordx4 v[176:179], v4, s[64:67], s13 offen sc1
    s_mov_b32 s13, 77824
    buffer_load_dwordx4 v[180:183], v4, s[64:67], s13 offen sc1
    s_mov_b32 s13, 90112
    buffer_load_dwordx4 v[184:187], v4, s[64:67], s13 offen sc1
    s_mov_b32 s13, 102400
    buffer_load_dwordx4 v[188:191], v4, s[64:67], s13 offen sc1
    s_add_u32 s96, s96, 1
    s_waitcnt vmcnt(0)
    s_cmp_lt_u32 s96, 0x80000
    s_cbranch_scc1 L_mchk_7
    s_branch L_mchk_7_ok
L_slow_9:
    buffer_store_dwordx4 v[16:19], v2, s[60:63], s9 offen sc1
    s_branch L_join_10
L_slow_11:
    buffer_store_dwordx4 v[20:23], v2, s[60:63], s89 offen sc1
    s_branch L_join_12
L_slow_13:
    buffer_store_dword v7, off, s[64:67], s8 offset:0 sc1
    s_branch L_join_14
L_mretry_18:
    v_accvgpr_read_b32 v10, a208
    s_nop 1
    s_mov_b32 s13, 65536
    buffer_load_dwordx4 v[112:115], v10, s[64:67], s13 offen sc1
    s_mov_b32 s13, 77824
    buffer_load_dwordx4 v[116:119], v10, s[64:67], s13 offen sc1
    s_mov_b32 s13, 90112
    buffer_load_dwordx4 v[120:123], v10, s[64:67], s13 offen sc1
    s_mov_b32 s13, 102400
    buffer_load_dwordx4 v[124:127], v10, s[64:67], s13 offen sc1
    s_add_u32 s96, s96, 1
    s_waitcnt vmcnt(0)
    s_cmp_lt_u32 s96, 0x80000
    s_cbranch_scc1 L_mchk_17
    s_branch L_mchk_17_ok
L_slow_19:
    buffer_store_dwordx2 v[40:41], v2, s[64:67], s89 offen sc1
    s_branch L_join_20
L_slow_21:
    buffer_store_dwordx4 v[32:35], v2, s[60:63], s89 offen offset:0 sc1
    s_branch L_join_22
L_slow_23:
    buffer_store_dwordx4 v[36:39], v2, s[60:63], s89 offen offset:1024 sc1
    s_branch L_join_24
L_slow_25:
    buffer_store_dword v7, off, s[64:67], s8 offset:256 sc1
    s_branch L_join_26
L_slow_29:
    buffer_store_dword v7, off, s[64:67], s8 offset:1280 sc1
    s_branch L_join_30
L_slow_31:
    buffer_store_dword v7, off, s[64:67], s8 offset:1024 sc1
    s_branch L_join_32
L_f_33_r:
    s_mov_b32 s96, 0
L_f_33_l:
    buffer_load_dword v158, v3, s[64:67], s74 offen offset:1280 sc1
    s_add_u32 s96, s96, 1
    s_waitcnt vmcnt(0)
    v_cmp_eq_u32 vcc, s75, v158
    s_nop 1
    s_and_b64 s[94:95], vcc, s[92:93]
    s_cmp_eq_u64 s[94:95], s[92:93]
    s_cbranch_scc1 L_f_33_ok
    s_cmp_lt_u32 s96, 0x80000
    s_cbranch_scc1 L_f_33_l
    s_branch L_f_33_ok
L_slow_34:
    buffer_store_dwordx4 v[144:147], v2, s[60:63], s16 offen offset:0 sc1
    s_branch L_join_35
L_epoch:
    v_lshrrev_b32 v8, 4, v1
    v_lshlrev_b32 v8, 20, v8
    v_and_b32 v9, 15, v1
    v_lshl_add_u32 v8, v9, 7, v8
    s_mov_b32 s96, 0
L_ep:
    s_mov_b64 s[94:95], -1
    s_mov_b32 s88, 2099204
    buffer_load_dword v16, v8, s[64:67], s88 offen sc1
    s_mov_b32 s88, 6293508
    buffer_load_dword v17, v8, s[64:67], s88 offen sc1
    s_mov_b32 s88, 10487812
    buffer_load_dword v18, v8, s[64:67], s88 offen sc1
    s_mov_b32 s88, 14682116
    buffer_load_dword v19, v8, s[64:67], s88 offen sc1
    s_waitcnt vmcnt(0)
    v_cmp_eq_u32 vcc, s75, v16
    s_nop 1
    s_and_b64 s[94:95], s[94:95], vcc
    v_cmp_eq_u32 vcc, s75, v17
    s_nop 1
    s_and_b64 s[94:95], s[94:95], vcc
    v_cmp_eq_u32 vcc, s75, v18
    s_nop 1
    s_and_b64 s[94:95], s[94:95], vcc
    v_cmp_eq_u32 vcc, s75, v19
    s_nop 1
    s_and_b64 s[94:95], s[94:95], vcc
    s_add_u32 s96, s96, 1
    s_cmp_eq_u64 s[94:95], -1
    s_cbranch_scc1 L_epd
    s_cmp_lt_u32 s96, 0x80000
    s_cbranch_scc1 L_ep
L_epd:
    v_mov_b32 v8, s75
    s_mov_b64 exec, 1
    buffer_store_dword v8, off, s[64:67], 0 sc1
    s_mov_b64 exec, -1
    s_branch L_epret
L_f_36_r:
    s_mov_b32 s96, 0
L_f_36_l:
    buffer_load_dword v159, v3, s[64:67], s74 offen offset:1024 sc1
    s_add_u32 s96, s96, 1
    s_waitcnt vmcnt(0)
    v_cmp_eq_u32 vcc, s75, v159
    s_nop 1
    s_and_b64 s[94:95], vcc, s[54:55]
    s_cmp_eq_u64 s[94:95], s[54:55]
    s_cbranch_scc1 L_f_36_ok
    s_cmp_lt_u32 s96, 0x80000
    s_cbranch_scc1 L_f_36_l
    s_branch L_f_36_ok
L_slow_37:
    buffer_store_dwordx4 v[148:151], v2, s[60:63], s16 offen offset:1024 sc1
    s_branch L_join_38
L_slow_39:
    buffer_store_dword v7, off, s[64:67], s8 offset:768 sc1
    s_branch L_join_40
L_slow_41:
    buffer_store_dword v7, off, s[64:67], s8 offset:512 sc1
    s_branch L_join_42
L_f_43_r:
    s_mov_b32 s96, 0
L_f_43_l:
    buffer_load_dword v159, v3, s[64:67], s74 offen offset:768 sc1
    s_add_u32 s96, s96, 1
    s_waitcnt vmcnt(0)
    v_cmp_eq_u32 vcc, s75, v159
    s_nop 1
    s_and_b64 s[94:95], vcc, s[54:55]
    s_cmp_eq_u64 s[94:95], s[54:55]
    s_cbranch_scc1 L_f_43_ok
    s_cmp_lt_u32 s96, 0x80000
    s_cbranch_scc1 L_f_43_l
    s_branch L_f_43_ok
L_f_44_r:
    s_mov_b32 s96, 0
L_f_44_l:
    buffer_load_dword v158, v3, s[64:67], s74 offen offset:512 sc1
    s_add_u32 s96, s96, 1
    s_waitcnt vmcnt(0)
    v_cmp_eq_u32 vcc, s75, v158
    s_nop 1
    s_and_b64 s[94:95], vcc, s[54:55]
    s_cmp_eq_u64 s[94:95], s[54:55]
    s_cbranch_scc1 L_f_44_ok
    s_cmp_lt_u32 s96, 0x80000
    s_cbranch_scc1 L_f_44_l
    s_branch L_f_44_ok
L_slow_45:
    buffer_store_dword v7, off, s[64:67], s8 offset:1536 sc1
    s_branch L_join_46
L_f_47_r:
    s_mov_b32 s96, 0
L_f_47_l:
    buffer_load_dword v159, v3, s[64:67], s74 offen offset:1536 sc1
    s_add_u32 s96, s96, 1
    s_waitcnt vmcnt(0)
    v_cmp_eq_u32 vcc, s75, v159
    s_nop 1
    s_and_b64 s[94:95], vcc, s[92:93]
    s_cmp_eq_u64 s[94:95], s[92:93]
    s_cbranch_scc1 L_f_47_ok
    s_cmp_lt_u32 s96, 0x80000
    s_cbranch_scc1 L_f_47_l
    s_branch L_f_47_ok
.section .rodata,"a"
.p2align 6
.amdhsa_kernel adaLN_cond__sliding_local_dilated__glu_gated_glu__prompt_kernel
  .amdhsa_next_free_vgpr 512
  .amdhsa_next_free_sgpr 102
  .amdhsa_accum_offset 256
  .amdhsa_group_segment_fixed_size 0
  .amdhsa_kernarg_size 96
  .amdhsa_user_sgpr_count 2
  .amdhsa_user_sgpr_kernarg_segment_ptr 1
  .amdhsa_system_sgpr_workgroup_id_x 1
.end_amdhsa_kernel
```
